```python
import torch

def _softmax(x, axis=-1):
    return torch.softmax(x, dim=axis)
def _gelu(x):
    return torch.nn.functional.gelu(x, approximate="tanh")
def _silu(x):
    return torch.nn.functional.silu(x)
def _sigmoid(x):
    return torch.sigmoid(x)
def _layernorm(x, axis=-1, eps=1e-5):
    m = x.mean(dim=axis, keepdim=True)
    v = x.var(dim=axis, keepdim=True, unbiased=False)
    return (x - m) / torch.sqrt(v + eps)
def _scatter_add(tgt, idx, src, axis=0):
    return tgt.clone().index_add_(axis, idx, src)
def _segment_sum(src, seg, n):
    out = torch.zeros((n,) + src.shape[1:], dtype=src.dtype)
    return out.index_add_(0, seg, src)
def _pad(x, pw):
    flat = tuple(v for pair in reversed(pw) for v in pair)
    return torch.nn.functional.pad(x, flat)

kernel_name = 'concat_heads__compressed_kv_cla__compressed_kv_cla__decode'

def setup_inputs():

    _w = (lambda a: (lambda t: t.to(torch.bfloat16) if t.is_floating_point() else t)(torch.as_tensor(a)))
    def _A_setup():
        B, H, Sq, Sk, D, M = 1, 32, 1, 4096, 128, 640
        Dc = 4 * D
        return {
            "x": _w((lambda *s: torch.randn(*s, dtype=torch.bfloat16) * 3.2)(B, Sq, M)),
            "c_kv": _w((lambda *s: torch.randn(*s, dtype=torch.bfloat16) * 0.05)(B, Sk, Dc)),
            "w_q": _w((lambda *s: torch.randn(*s, dtype=torch.bfloat16) * 3.2)(M, H, D) * (M ** -0.5)),
            "w_uk": _w((lambda *s: torch.randn(*s, dtype=torch.bfloat16) * 3.2)(Dc, H, D) * (Dc ** -0.5)),
            "w_uv": _w((lambda *s: torch.randn(*s, dtype=torch.bfloat16) * 0.05)(Dc, H, D) * (Dc ** -0.5)),
            "w_o": _w((lambda *s: torch.randn(*s, dtype=torch.bfloat16) * 0.05)(H, D, M) * ((H * D) ** -0.5)),
        }
    _A_in = _A_setup()

    def _B_setup():
        B, H, Sq, Sk, D, M = 1, 32, 1, 4096, 128, 640
        Dc = 4 * D
        return {
            "x": _w((lambda *s: torch.randn(*s, dtype=torch.bfloat16) * 3.2)(B, Sq, M)),
            "c_kv": _w((lambda *s: torch.randn(*s, dtype=torch.bfloat16) * 0.05)(B, Sk, Dc)),
            "w_q": _w((lambda *s: torch.randn(*s, dtype=torch.bfloat16) * 3.2)(M, H, D) * (M ** -0.5)),
            "w_uk": _w((lambda *s: torch.randn(*s, dtype=torch.bfloat16) * 3.2)(Dc, H, D) * (Dc ** -0.5)),
            "w_uv": _w((lambda *s: torch.randn(*s, dtype=torch.bfloat16) * 0.05)(Dc, H, D) * (Dc ** -0.5)),
            "w_o": _w((lambda *s: torch.randn(*s, dtype=torch.bfloat16) * 0.05)(H, D, M) * ((H * D) ** -0.5)),
        }
    _B_in = _B_setup()

    return {
        "A_x": _A_in["x"],
        "A_c_kv": _A_in["c_kv"],
        "A_w_q": _A_in["w_q"],
        "A_w_uk": _A_in["w_uk"],
        "A_w_uv": _A_in["w_uv"],
        "A_w_o": _A_in["w_o"],
        "B_x": _B_in["x"],
        "B_c_kv": _B_in["c_kv"],
        "B_w_q": _B_in["w_q"],
        "B_w_uk": _B_in["w_uk"],
        "B_w_uv": _B_in["w_uv"],
        "B_w_o": _B_in["w_o"],
    }

def reference(A_x, A_c_kv, A_w_q, A_w_uk, A_w_uv, A_w_o, B_x, B_c_kv, B_w_q, B_w_uk, B_w_uv, B_w_o):
    def _A_ref(x, c_kv, w_q, w_uk, w_uv, w_o):
        B, Sq, M = x.shape[0], x.shape[1], x.shape[2]
        Sk = c_kv.shape[1]
        H, D = w_q.shape[1], w_q.shape[2]
        q = torch.einsum("bqm,mhd->bhqd", x, w_q)
        k = torch.einsum("bkc,chd->bhkd", c_kv, w_uk)
        v = torch.einsum("bkc,chd->bhkd", c_kv, w_uv)
        scores = torch.einsum("bhqd,bhkd->bhqk", q, k) * (D ** -0.5)
        off = Sk - Sq
        qi = torch.arange(Sq)[:, None]
        kj = torch.arange(Sk)[None, :]
        cmask = kj <= (qi + off)
        scores = torch.where(cmask[None, None], scores, -1e9)
        p = _softmax(scores, axis=-1)
        ctx = torch.einsum("bhqk,bhkd->bhqd", p, v)
        return torch.einsum("bhqd,hdm->bqm", ctx, w_o)

    def _B_ref(x, c_kv, w_q, w_uk, w_uv, w_o):
        B, Sq, M = x.shape[0], x.shape[1], x.shape[2]
        Sk = c_kv.shape[1]
        H, D = w_q.shape[1], w_q.shape[2]
        q = torch.einsum("bqm,mhd->bhqd", x, w_q)
        k = torch.einsum("bkc,chd->bhkd", c_kv, w_uk)
        v = torch.einsum("bkc,chd->bhkd", c_kv, w_uv)
        scores = torch.einsum("bhqd,bhkd->bhqk", q, k) * (D ** -0.5)
        off = Sk - Sq
        qi = torch.arange(Sq)[:, None]
        kj = torch.arange(Sk)[None, :]
        cmask = kj <= (qi + off)
        scores = torch.where(cmask[None, None], scores, -1e9)
        p = _softmax(scores, axis=-1)
        ctx = torch.einsum("bhqk,bhkd->bhqd", p, v)
        return torch.einsum("bhqd,hdm->bqm", ctx, w_o)

    a = _A_ref(A_x, A_c_kv, A_w_q, A_w_uk, A_w_uv, A_w_o)
    b = _B_ref(B_x, B_c_kv, B_w_q, B_w_uk, B_w_uv, B_w_o)
    return torch.concatenate([a, b], axis=-1)
```

```asm
; @launch grid=(256,1,1) block=(512,1,1) lds=160272
.amdgcn_target "amdgcn-amd-amdhsa--gfx950"
.text
.globl concat_heads__compressed_kv_cla__compressed_kv_cla__decode_kernel
.p2align 8
.type concat_heads__compressed_kv_cla__compressed_kv_cla__decode_kernel,@function
concat_heads__compressed_kv_cla__compressed_kv_cla__decode_kernel:
    s_cmp_ge_u32 s2, 256
    s_cbranch_scc1 L_end
    s_bfe_u32 s4, s2, 0x10002
    s_mul_i32 s3, s4, 48
    s_add_u32 s34, s0, s3
    s_addc_u32 s35, s1, 0
    s_load_dwordx4 s[8:11], s[34:35], 0
    s_load_dwordx4 s[12:15], s[34:35], 16
    s_load_dwordx4 s[16:19], s[34:35], 32
    s_load_dwordx4 s[20:23], s[0:1], 96
    s_load_dwordx2 s[24:25], s[0:1], 112
    v_lshrrev_b32 v4, 6, v0
    v_and_b32 v1, 63, v0
    v_readfirstlane_b32 s31, v4
    s_and_b32 s5, s2, 3
    s_lshr_b32 s6, s2, 3
    s_and_b32 s7, s6, 7
    s_lshl_b32 s28, s5, 3
    s_lshr_b32 s3, s6, 2
    s_add_u32 s28, s28, s3
    s_and_b32 s27, s28, 30
    s_bfe_u32 s29, s6, 0x10001
    s_and_b32 s30, s6, 1
    s_lshl_b32 s26, s4, 5
    s_add_u32 s26, s26, s28
    v_lshlrev_b32 v7, 4, v1
    s_cmp_ge_u32 s31, 4
    s_cbranch_scc1 L_S
    v_lshrrev_b32 v4, 5, v1
    v_and_b32 v44, 31, v1
    s_lshr_b32 s3, s7, 1
    s_lshl_b32 s3, s3, 2
    s_add_u32 s65, s3, s31
    s_cmp_eq_u32 s30, 0
    s_cselect_b32 s39, 20, 20
    s_cselect_b32 s37, 0, 640
    s_mul_i32 s3, s65, s39
    s_lshl_b32 s3, s3, 1
    s_add_u32 s37, s37, s3
    v_mul_u32_u24 v3, s39, v4
    v_lshlrev_b32 v2, 12, v3
    v_lshl_add_u32 v2, v44, 4, v2
    s_lshl_b32 s36, s37, 12
    s_lshl_b32 s38, s27, 8
    s_add_u32 s36, s36, s38
    s_mov_b32 s39, 0
    s_waitcnt lgkmcnt(0)
    s_mov_b32 s40, s8
    s_mov_b32 s41, s9
    s_mov_b32 s42, 1280
    s_mov_b32 s43, 0x20000
    s_add_u32 s44, s12, s36
    s_addc_u32 s45, s13, 0
    s_sub_u32 s46, 5242880, s36
    s_mov_b32 s47, 0x20000
    buffer_load_dwordx4 v[52:55], v3, s[40:43], s37 offen
    buffer_load_dwordx4 v[56:59], v3, s[40:43], s37 offen offset:16
    buffer_load_dwordx4 v[64:67], v2, s[44:47], s39 offen nt
    s_add_u32 s39, s39, 8192
    buffer_load_dwordx4 v[68:71], v2, s[44:47], s39 offen nt
    s_add_u32 s39, s39, 8192
    buffer_load_dwordx4 v[72:75], v2, s[44:47], s39 offen nt
    s_add_u32 s39, s39, 8192
    buffer_load_dwordx4 v[76:79], v2, s[44:47], s39 offen nt
    s_add_u32 s39, s39, 8192
    buffer_load_dwordx4 v[80:83], v2, s[44:47], s39 offen nt
    s_add_u32 s39, s39, 8192
    buffer_load_dwordx4 v[84:87], v2, s[44:47], s39 offen nt
    s_add_u32 s39, s39, 8192
    v_and_b32 v46, 1, v1
    v_cmp_eq_u32 vcc, 1, v46
    v_mov_b32 v47, 0x0c0c0100
    v_mov_b32 v48, 0x01000c0c
    v_cndmask_b32 v47, v47, v48, vcc
    v_mov_b32 v48, 0x0c0c0302
    v_mov_b32 v49, 0x03020c0c
    v_cndmask_b32 v48, v48, v49, vcc
    v_mov_b32 v49, 0x0c0c0c0c
    v_bfe_u32 v46, v1, 1, 2
    v_cmp_eq_u32 vcc, 0, v46
    s_nop 1
    v_cndmask_b32 v8, v49, v47, vcc
    v_cndmask_b32 v12, v49, v48, vcc
    v_cmp_eq_u32 vcc, 1, v46
    s_nop 1
    v_cndmask_b32 v9, v49, v47, vcc
    v_cndmask_b32 v13, v49, v48, vcc
    v_cmp_eq_u32 vcc, 2, v46
    s_nop 1
    v_cndmask_b32 v10, v49, v47, vcc
    v_cndmask_b32 v14, v49, v48, vcc
    v_cmp_eq_u32 vcc, 3, v46
    s_nop 1
    v_cndmask_b32 v11, v49, v47, vcc
    v_cndmask_b32 v15, v49, v48, vcc
    s_mov_b32 vcc_lo, 0xff0000ff
    s_mov_b32 vcc_hi, 0xff0000ff
    v_cndmask_b32 v16, v49, v8, vcc
    v_cndmask_b32 v17, v49, v9, vcc
    v_cndmask_b32 v18, v49, v10, vcc
    v_cndmask_b32 v19, v49, v11, vcc
    v_cndmask_b32 v20, v49, v12, vcc
    v_cndmask_b32 v21, v49, v13, vcc
    v_cndmask_b32 v22, v49, v14, vcc
    v_cndmask_b32 v23, v49, v15, vcc
    s_mov_b32 s40, s24
    s_mov_b32 s41, s25
    s_mov_b32 s42, 4194304
    v_lshlrev_b32 v30, 9, v4
    v_and_b32 v46, 15, v1
    v_lshl_add_u32 v30, v46, 5, v30
    v_and_b32 v47, 16, v1
    v_add_u32 v30, v30, v47
    s_lshl_b32 s3, s31, 10
    s_add_u32 s3, s3, 152064
    v_add_u32 v30, s3, v30
    s_lshl_b32 s3, s31, 8
    s_add_u32 s3, s3, 152064
    v_lshl_add_u32 v31, v1, 3, s3
    s_lshr_b32 s62, s26, 1
    s_lshl_b32 s62, s62, 3
    s_add_u32 s62, s62, s7
    s_lshl_b32 s62, s62, 2
    s_add_u32 s62, s62, s31
    s_lshl_b32 s62, s62, 9
    s_add_u32 s62, s62, 131072
    v_mov_b32 v29, 160256
    s_cmp_eq_u32 s30, 0
    s_cbranch_scc1 L_PU
    s_lshl_b32 s3, s28, 17
    s_add_u32 s52, s10, s3
    s_addc_u32 s53, s11, 0
    s_sub_u32 s54, 4194304, s3
    s_mov_b32 s55, 0x20000
    s_lshl_b32 s64, s29, 2
    s_add_u32 s64, s64, s31
    s_xor_b32 s65, s64, 4
    s_lshl_b32 s64, s64, 14
    s_lshl_b32 s65, s65, 14
    s_mul_i32 s66, s31, 33792
    s_lshr_b32 s3, s7, 1
    s_lshl_b32 s3, s3, 2
    s_add_u32 s3, s3, s31
    s_lshl_b32 s3, s3, 18
    s_add_u32 s3, s3, s38
    s_add_u32 s48, s14, s3
    s_addc_u32 s49, s15, 0
    s_sub_u32 s50, 4194304, s3
    s_mov_b32 s51, 0x20000
    v_lshlrev_b32 v5, 17, v4
    v_lshl_add_u32 v5, v44, 4, v5
    s_waitcnt vmcnt(6)
    v_perm_b32 v32, v52, v52, v16
    v_perm_b32 v33, v52, v52, v17
    v_perm_b32 v34, v52, v52, v18
    v_perm_b32 v35, v52, v52, v19
    s_waitcnt vmcnt(5)
    buffer_load_dwordx4 v[88:91], v2, s[44:47], s39 offen nt
    s_add_u32 s39, s39, 8192
    v_perm_b32 v36, v52, v52, v20
    v_perm_b32 v37, v52, v52, v21
    v_perm_b32 v38, v52, v52, v22
    v_perm_b32 v39, v52, v52, v23
    v_mfma_f32_16x16x32_bf16 v[40:43], v[32:35], v[64:67], 0
    s_waitcnt vmcnt(5)
    buffer_load_dwordx4 v[92:95], v2, s[44:47], s39 offen nt
    s_add_u32 s39, s39, 8192
    v_perm_b32 v32, v53, v53, v16
    v_perm_b32 v33, v53, v53, v17
    v_perm_b32 v34, v53, v53, v18
    v_perm_b32 v35, v53, v53, v19
    v_mfma_f32_16x16x32_bf16 v[40:43], v[36:39], v[68:71], v[40:43]
    s_waitcnt vmcnt(5)
    buffer_load_dwordx4 v[96:99], v2, s[44:47], s39 offen nt
    s_add_u32 s39, s39, 8192
    v_perm_b32 v36, v53, v53, v20
    v_perm_b32 v37, v53, v53, v21
    v_perm_b32 v38, v53, v53, v22
    v_perm_b32 v39, v53, v53, v23
    v_mfma_f32_16x16x32_bf16 v[40:43], v[32:35], v[72:75], v[40:43]
    s_waitcnt vmcnt(5)
    buffer_load_dwordx4 v[100:103], v2, s[44:47], s39 offen nt
    s_add_u32 s39, s39, 8192
    v_perm_b32 v32, v54, v54, v16
    v_perm_b32 v33, v54, v54, v17
    v_perm_b32 v34, v54, v54, v18
    v_perm_b32 v35, v54, v54, v19
    v_mfma_f32_16x16x32_bf16 v[40:43], v[36:39], v[76:79], v[40:43]
    s_waitcnt vmcnt(5)
    s_mov_b32 s67, 122880
    buffer_load_dwordx4 v[140:143], v5, s[48:51], s67 offen
    v_perm_b32 v36, v54, v54, v20
    v_perm_b32 v37, v54, v54, v21
    v_perm_b32 v38, v54, v54, v22
    v_perm_b32 v39, v54, v54, v23
    v_mfma_f32_16x16x32_bf16 v[40:43], v[32:35], v[80:83], v[40:43]
    s_waitcnt vmcnt(5)
    s_mov_b32 s67, 114688
    buffer_load_dwordx4 v[140:143], v5, s[48:51], s67 offen
    v_perm_b32 v32, v55, v55, v16
    v_perm_b32 v33, v55, v55, v17
    v_perm_b32 v34, v55, v55, v18
    v_perm_b32 v35, v55, v55, v19
    v_mfma_f32_16x16x32_bf16 v[40:43], v[36:39], v[84:87], v[40:43]
    s_waitcnt vmcnt(5)
    s_mov_b32 s67, 106496
    buffer_load_dwordx4 v[140:143], v5, s[48:51], s67 offen
    v_perm_b32 v36, v55, v55, v20
    v_perm_b32 v37, v55, v55, v21
    v_perm_b32 v38, v55, v55, v22
    v_perm_b32 v39, v55, v55, v23
    v_mfma_f32_16x16x32_bf16 v[40:43], v[32:35], v[88:91], v[40:43]
    s_waitcnt vmcnt(5)
    s_mov_b32 s67, 98304
    buffer_load_dwordx4 v[140:143], v5, s[48:51], s67 offen
    v_perm_b32 v32, v56, v56, v16
    v_perm_b32 v33, v56, v56, v17
    v_perm_b32 v34, v56, v56, v18
    v_perm_b32 v35, v56, v56, v19
    v_mfma_f32_16x16x32_bf16 v[40:43], v[36:39], v[92:95], v[40:43]
    s_waitcnt vmcnt(5)
    s_mov_b32 s67, 90112
    buffer_load_dwordx4 v[140:143], v5, s[48:51], s67 offen
    v_perm_b32 v36, v56, v56, v20
    v_perm_b32 v37, v56, v56, v21
    v_perm_b32 v38, v56, v56, v22
    v_perm_b32 v39, v56, v56, v23
    v_mfma_f32_16x16x32_bf16 v[40:43], v[32:35], v[96:99], v[40:43]
    s_waitcnt vmcnt(5)
    s_mov_b32 s67, 81920
    buffer_load_dwordx4 v[140:143], v5, s[48:51], s67 offen
    v_mfma_f32_16x16x32_bf16 v[40:43], v[36:39], v[100:103], v[40:43]
    s_nop 7
    ds_write_b128 v30, v[40:43]
    s_waitcnt lgkmcnt(0)
    s_barrier
    ds_read_b64 v[32:33], v31 offset:0
    ds_read_b64 v[34:35], v31 offset:1024
    ds_read_b64 v[36:37], v31 offset:2048
    ds_read_b64 v[38:39], v31 offset:3072
    ds_read_b64 v[42:43], v29
    s_waitcnt vmcnt(5)
    s_mov_b32 s67, 73728
    buffer_load_dwordx4 v[140:143], v5, s[48:51], s67 offen
    s_waitcnt lgkmcnt(0)
    v_add_f32 v32, v32, v34
    v_add_f32 v33, v33, v35
    v_add_f32 v36, v36, v38
    v_add_f32 v37, v37, v39
    v_add_f32 v40, v32, v36
    v_add_f32 v41, v33, v37
    s_mov_b32 exec_hi, 0
    buffer_store_dwordx4 v[40:43], v7, s[40:43], s62 offen sc1
    s_mov_b32 exec_hi, -1
    v_mov_b32 v16, v42
    v_mov_b32 v17, v43
    v_and_b32 v46, 15, v1
    v_lshrrev_b32 v47, 4, v1
    v_mul_u32_u24 v22, 1056, v46
    v_lshl_add_u32 v22, v47, 4, v22
    s_mul_i32 s3, s31, 33792
    v_add_u32 v21, s3, v22
    v_add_u32 v22, 135168, v22
    s_lshl_b32 s68, s31, 1
    s_lshl_b32 s60, s4, 1
    s_add_u32 s60, s60, s29
    s_lshl_b32 s61, s60, 5
    s_add_u32 s61, s61, s28
    s_lshl_b32 s61, s61, 8
    s_add_u32 s61, s61, 1572864
    s_lshl_b32 s60, s60, 9
    s_add_u32 s60, s60, s28
    s_lshl_b32 s60, s60, 3
    s_add_u32 s60, s60, s68
    s_lshl_b32 s60, s60, 7
    s_add_u32 s60, s60, 2097152
    v_and_b32 v46, 15, v1
    v_lshrrev_b32 v44, 2, v1
    v_mul_u32_u24 v23, 1056, v44
    v_and_b32 v44, 3, v1
    v_lshl_add_u32 v23, v44, 3, v23
    s_lshl_b32 s3, s68, 7
    v_add_u32 v23, s3, v23
    v_add_u32 v24, 67584, v23
    v_lshlrev_b32 v26, 15, v46
    v_and_b32 v44, 16, v1
    v_lshl_add_u32 v26, v44, 1, v26
    v_lshrrev_b32 v44, 5, v1
    v_lshl_add_u32 v26, v44, 4, v26
    v_add_u32 v27, 152064, v7
    v_add_u32 v20, 156160, v7
    s_lshl_b32 s3, s31, 2
    v_add_u32 v25, s3, v27
    s_lshl_b32 s3, s31, 10
    v_add_u32 v19, s3, v20
    s_waitcnt vmcnt(5)
    s_mov_b32 m0, s66
    s_add_u32 s66, s66, 1056
    buffer_load_dwordx4 v7, s[52:55], s64 offen  lds
    s_add_u32 s64, s64, 1024
    s_waitcnt vmcnt(5)
    s_mov_b32 m0, s66
    s_add_u32 s66, s66, 1056
    buffer_load_dwordx4 v7, s[52:55], s64 offen  lds
    s_add_u32 s64, s64, 1024
    s_waitcnt vmcnt(5)
    s_mov_b32 m0, s66
    s_add_u32 s66, s66, 1056
    buffer_load_dwordx4 v7, s[52:55], s64 offen  lds
    s_add_u32 s64, s64, 1024
    s_waitcnt vmcnt(5)
    s_mov_b32 m0, s66
    s_add_u32 s66, s66, 1056
    buffer_load_dwordx4 v7, s[52:55], s64 offen  lds
    s_add_u32 s64, s64, 1024
    s_waitcnt vmcnt(5)
    s_mov_b32 m0, s66
    s_add_u32 s66, s66, 1056
    buffer_load_dwordx4 v7, s[52:55], s64 offen  lds
    s_add_u32 s64, s64, 1024
    s_waitcnt vmcnt(5)
    s_mov_b32 m0, s66
    s_add_u32 s66, s66, 1056
    buffer_load_dwordx4 v7, s[52:55], s64 offen  lds
    s_add_u32 s64, s64, 1024
    s_waitcnt vmcnt(5)
    s_mov_b32 m0, s66
    s_add_u32 s66, s66, 1056
    buffer_load_dwordx4 v7, s[52:55], s64 offen  lds
    s_add_u32 s64, s64, 1024
    s_waitcnt vmcnt(5)
    s_mov_b32 m0, s66
    s_add_u32 s66, s66, 1056
    buffer_load_dwordx4 v7, s[52:55], s64 offen  lds
    s_add_u32 s64, s64, 1024
    s_waitcnt vmcnt(5)
    s_mov_b32 m0, s66
    s_add_u32 s66, s66, 1056
    buffer_load_dwordx4 v7, s[52:55], s64 offen  lds
    s_add_u32 s64, s64, 1024
    s_waitcnt vmcnt(5)
    s_mov_b32 m0, s66
    s_add_u32 s66, s66, 1056
    buffer_load_dwordx4 v7, s[52:55], s64 offen  lds
    s_add_u32 s64, s64, 1024
    s_waitcnt vmcnt(5)
    s_mov_b32 m0, s66
    s_add_u32 s66, s66, 1056
    buffer_load_dwordx4 v7, s[52:55], s64 offen  lds
    s_add_u32 s64, s64, 1024
    s_waitcnt vmcnt(5)
    s_mov_b32 m0, s66
    s_add_u32 s66, s66, 1056
    buffer_load_dwordx4 v7, s[52:55], s64 offen  lds
    s_add_u32 s64, s64, 1024
    s_waitcnt vmcnt(5)
    s_mov_b32 m0, s66
    s_add_u32 s66, s66, 1056
    buffer_load_dwordx4 v7, s[52:55], s64 offen  lds
    s_add_u32 s64, s64, 1024
    s_waitcnt vmcnt(5)
    s_mov_b32 m0, s66
    s_add_u32 s66, s66, 1056
    buffer_load_dwordx4 v7, s[52:55], s64 offen  lds
    s_add_u32 s64, s64, 1024
    s_waitcnt vmcnt(5)
    s_mov_b32 m0, s66
    s_add_u32 s66, s66, 1056
    buffer_load_dwordx4 v7, s[52:55], s64 offen  lds
    s_add_u32 s64, s64, 1024
    s_waitcnt vmcnt(5)
    s_mov_b32 m0, s66
    s_add_u32 s66, s66, 1056
    buffer_load_dwordx4 v7, s[52:55], s64 offen  lds
    s_add_u32 s64, s64, 1024
    s_mov_b32 m0, s66
    s_add_u32 s66, s66, 1056
    buffer_load_dwordx4 v7, s[52:55], s65 offen  lds
    s_add_u32 s65, s65, 1024
    s_mov_b32 m0, s66
    s_add_u32 s66, s66, 1056
    buffer_load_dwordx4 v7, s[52:55], s65 offen  lds
    s_add_u32 s65, s65, 1024
    s_waitcnt vmcnt(7)
    s_mov_b32 m0, s66
    s_add_u32 s66, s66, 1056
    buffer_load_dwordx4 v7, s[52:55], s65 offen  lds
    s_add_u32 s65, s65, 1024
    s_waitcnt vmcnt(7)
    s_mov_b32 m0, s66
    s_add_u32 s66, s66, 1056
    buffer_load_dwordx4 v7, s[52:55], s65 offen  lds
    s_add_u32 s65, s65, 1024
    s_waitcnt vmcnt(7)
    s_mov_b32 m0, s66
    s_add_u32 s66, s66, 1056
    buffer_load_dwordx4 v7, s[52:55], s65 offen  lds
    s_add_u32 s65, s65, 1024
    s_waitcnt vmcnt(7)
    s_mov_b32 m0, s66
    s_add_u32 s66, s66, 1056
    buffer_load_dwordx4 v7, s[52:55], s65 offen  lds
    s_add_u32 s65, s65, 1024
    s_waitcnt vmcnt(7)
    s_mov_b32 m0, s66
    s_add_u32 s66, s66, 1056
    buffer_load_dwordx4 v7, s[52:55], s65 offen  lds
    s_add_u32 s65, s65, 1024
    s_waitcnt vmcnt(7)
    s_mov_b32 m0, s66
    s_add_u32 s66, s66, 1056
    buffer_load_dwordx4 v7, s[52:55], s65 offen  lds
    s_add_u32 s65, s65, 1024
    s_waitcnt vmcnt(7)
    s_mov_b32 m0, s66
    s_add_u32 s66, s66, 1056
    buffer_load_dwordx4 v7, s[52:55], s65 offen  lds
    s_add_u32 s65, s65, 1024
    s_waitcnt vmcnt(7)
    s_mov_b32 m0, s66
    s_add_u32 s66, s66, 1056
    buffer_load_dwordx4 v7, s[52:55], s65 offen  lds
    s_add_u32 s65, s65, 1024
    s_waitcnt vmcnt(7)
    s_mov_b32 m0, s66
    s_add_u32 s66, s66, 1056
    buffer_load_dwordx4 v7, s[52:55], s65 offen  lds
    s_add_u32 s65, s65, 1024
    s_waitcnt vmcnt(7)
    s_mov_b32 m0, s66
    s_add_u32 s66, s66, 1056
    buffer_load_dwordx4 v7, s[52:55], s65 offen  lds
    s_add_u32 s65, s65, 1024
    s_waitcnt vmcnt(7)
    s_mov_b32 m0, s66
    s_add_u32 s66, s66, 1056
    buffer_load_dwordx4 v7, s[52:55], s65 offen  lds
    s_add_u32 s65, s65, 1024
    s_waitcnt vmcnt(7)
    s_mov_b32 m0, s66
    s_add_u32 s66, s66, 1056
    buffer_load_dwordx4 v7, s[52:55], s65 offen  lds
    s_add_u32 s65, s65, 1024
    s_waitcnt vmcnt(7)
    s_mov_b32 m0, s66
    s_add_u32 s66, s66, 1056
    buffer_load_dwordx4 v7, s[52:55], s65 offen  lds
    s_add_u32 s65, s65, 1024
    s_waitcnt vmcnt(7)
    s_mov_b32 m0, s66
    s_add_u32 s66, s66, 1056
    buffer_load_dwordx4 v7, s[52:55], s65 offen  lds
    s_add_u32 s65, s65, 1024
    s_barrier
    s_waitcnt vmcnt(0)
    ds_read_b128 v[128:131], v21 offset:0
    ds_read_b128 v[132:135], v21 offset:16896
    ds_read_b128 v[136:139], v21 offset:64
    ds_read_b128 v[140:143], v21 offset:16960
    ds_read_b128 v[144:147], v21 offset:128
    ds_read_b128 v[148:151], v21 offset:17024
    ds_read_b128 v[152:155], v21 offset:192
    ds_read_b128 v[156:159], v21 offset:17088
    ds_read_b128 v[160:163], v21 offset:256
    ds_read_b128 v[164:167], v21 offset:17152
    ds_read_b128 v[168:171], v21 offset:320
    ds_read_b128 v[172:175], v21 offset:17216
    ds_read_b128 v[176:179], v21 offset:384
    ds_read_b128 v[180:183], v21 offset:17280
    ds_read_b128 v[184:187], v21 offset:448
    ds_read_b128 v[188:191], v21 offset:17344
    ds_read_b128 v[192:195], v21 offset:512
    ds_read_b128 v[196:199], v21 offset:17408
    ds_read_b128 v[200:203], v21 offset:576
    ds_read_b128 v[204:207], v21 offset:17472
    ds_read_b128 v[208:211], v21 offset:640
    ds_read_b128 v[212:215], v21 offset:17536
    ds_read_b128 v[216:219], v21 offset:704
    ds_read_b128 v[220:223], v21 offset:17600
    ds_read_b128 v[224:227], v21 offset:768
    ds_read_b128 v[228:231], v21 offset:17664
    ds_read_b128 v[232:235], v21 offset:832
    ds_read_b128 v[236:239], v21 offset:17728
    ds_read_b128 v[240:243], v21 offset:896
    ds_read_b128 v[244:247], v21 offset:17792
    ds_read_b128 v[248:251], v21 offset:960
    ds_read_b128 v[252:255], v21 offset:17856
    s_barrier
    ds_read_b128 v[48:51], v22 offset:0
    ds_read_b128 v[52:55], v22 offset:64
    ds_read_b128 v[56:59], v22 offset:128
    ds_read_b128 v[60:63], v22 offset:192
    ds_read_b128 v[64:67], v22 offset:256
    ds_read_b128 v[68:71], v22 offset:320
    s_waitcnt lgkmcnt(5)
    v_mfma_f32_16x16x32_bf16 v[112:115], v[128:131], v[48:51], 0
    v_mfma_f32_16x16x32_bf16 v[116:119], v[132:135], v[48:51], 0
    ds_read_b128 v[72:75], v22 offset:384
    s_waitcnt lgkmcnt(5)
    v_mfma_f32_16x16x32_bf16 v[112:115], v[136:139], v[52:55], v[112:115]
    v_mfma_f32_16x16x32_bf16 v[116:119], v[140:143], v[52:55], v[116:119]
    ds_read_b128 v[76:79], v22 offset:448
    ds_read_b64_tr_b16 v[128:129], v23 offset:0
    ds_read_b64_tr_b16 v[130:131], v23 offset:16896
    s_waitcnt lgkmcnt(7)
    v_mfma_f32_16x16x32_bf16 v[112:115], v[144:147], v[56:59], v[112:115]
    v_mfma_f32_16x16x32_bf16 v[116:119], v[148:151], v[56:59], v[116:119]
    ds_read_b128 v[80:83], v22 offset:512
    ds_read_b64_tr_b16 v[132:133], v23 offset:33792
    ds_read_b64_tr_b16 v[134:135], v23 offset:50688
    s_waitcnt lgkmcnt(9)
    v_mfma_f32_16x16x32_bf16 v[112:115], v[152:155], v[60:63], v[112:115]
    v_mfma_f32_16x16x32_bf16 v[116:119], v[156:159], v[60:63], v[116:119]
    ds_read_b128 v[84:87], v22 offset:576
    ds_read_b64_tr_b16 v[136:137], v24 offset:0
    ds_read_b64_tr_b16 v[138:139], v24 offset:16896
    s_waitcnt lgkmcnt(11)
    v_mfma_f32_16x16x32_bf16 v[112:115], v[160:163], v[64:67], v[112:115]
    v_mfma_f32_16x16x32_bf16 v[116:119], v[164:167], v[64:67], v[116:119]
    ds_read_b128 v[88:91], v22 offset:640
    ds_read_b64_tr_b16 v[140:141], v24 offset:33792
    ds_read_b64_tr_b16 v[142:143], v24 offset:50688
    s_waitcnt lgkmcnt(13)
    v_mfma_f32_16x16x32_bf16 v[112:115], v[168:171], v[68:71], v[112:115]
    v_mfma_f32_16x16x32_bf16 v[116:119], v[172:175], v[68:71], v[116:119]
    ds_read_b128 v[92:95], v22 offset:704
    ds_read_b64_tr_b16 v[144:145], v23 offset:32
    ds_read_b64_tr_b16 v[146:147], v23 offset:16928
    s_waitcnt lgkmcnt(15)
    v_mfma_f32_16x16x32_bf16 v[112:115], v[176:179], v[72:75], v[112:115]
    v_mfma_f32_16x16x32_bf16 v[116:119], v[180:183], v[72:75], v[116:119]
    ds_read_b128 v[96:99], v22 offset:768
    ds_read_b64_tr_b16 v[148:149], v23 offset:33824
    ds_read_b64_tr_b16 v[150:151], v23 offset:50720
    s_waitcnt lgkmcnt(15)
    v_mfma_f32_16x16x32_bf16 v[112:115], v[184:187], v[76:79], v[112:115]
    v_mfma_f32_16x16x32_bf16 v[116:119], v[188:191], v[76:79], v[116:119]
    ds_read_b128 v[100:103], v22 offset:832
    ds_read_b64_tr_b16 v[152:153], v24 offset:32
    ds_read_b64_tr_b16 v[154:155], v24 offset:16928
    s_waitcnt lgkmcnt(15)
    v_mfma_f32_16x16x32_bf16 v[112:115], v[192:195], v[80:83], v[112:115]
    v_mfma_f32_16x16x32_bf16 v[116:119], v[196:199], v[80:83], v[116:119]
    ds_read_b128 v[104:107], v22 offset:896
    ds_read_b64_tr_b16 v[156:157], v24 offset:33824
    ds_read_b64_tr_b16 v[158:159], v24 offset:50720
    s_waitcnt lgkmcnt(15)
    v_mfma_f32_16x16x32_bf16 v[112:115], v[200:203], v[84:87], v[112:115]
    v_mfma_f32_16x16x32_bf16 v[116:119], v[204:207], v[84:87], v[116:119]
    ds_read_b128 v[108:111], v22 offset:960
    ds_read_b64_tr_b16 v[160:161], v23 offset:64
    ds_read_b64_tr_b16 v[162:163], v23 offset:16960
    s_waitcnt lgkmcnt(15)
    v_mfma_f32_16x16x32_bf16 v[112:115], v[208:211], v[88:91], v[112:115]
    v_mfma_f32_16x16x32_bf16 v[116:119], v[212:215], v[88:91], v[116:119]
    ds_read_b64_tr_b16 v[164:165], v23 offset:33856
    ds_read_b64_tr_b16 v[166:167], v23 offset:50752
    s_waitcnt lgkmcnt(15)
    v_mfma_f32_16x16x32_bf16 v[112:115], v[216:219], v[92:95], v[112:115]
    v_mfma_f32_16x16x32_bf16 v[116:119], v[220:223], v[92:95], v[116:119]
    ds_read_b64_tr_b16 v[168:169], v24 offset:64
    ds_read_b64_tr_b16 v[170:171], v24 offset:16960
    s_waitcnt lgkmcnt(15)
    v_mfma_f32_16x16x32_bf16 v[112:115], v[224:227], v[96:99], v[112:115]
    v_mfma_f32_16x16x32_bf16 v[116:119], v[228:231], v[96:99], v[116:119]
    ds_read_b64_tr_b16 v[172:173], v24 offset:33856
    ds_read_b64_tr_b16 v[174:175], v24 offset:50752
    s_waitcnt lgkmcnt(14)
    v_mfma_f32_16x16x32_bf16 v[112:115], v[232:235], v[100:103], v[112:115]
    v_mfma_f32_16x16x32_bf16 v[116:119], v[236:239], v[100:103], v[116:119]
    ds_read_b64_tr_b16 v[176:177], v23 offset:96
    ds_read_b64_tr_b16 v[178:179], v23 offset:16992
    s_waitcnt lgkmcnt(13)
    v_mfma_f32_16x16x32_bf16 v[112:115], v[240:243], v[104:107], v[112:115]
    v_mfma_f32_16x16x32_bf16 v[116:119], v[244:247], v[104:107], v[116:119]
    ds_read_b64_tr_b16 v[180:181], v23 offset:33888
    ds_read_b64_tr_b16 v[182:183], v23 offset:50784
    s_waitcnt lgkmcnt(12)
    v_mfma_f32_16x16x32_bf16 v[112:115], v[248:251], v[108:111], v[112:115]
    v_mfma_f32_16x16x32_bf16 v[116:119], v[252:255], v[108:111], v[116:119]
    ds_read_b64_tr_b16 v[184:185], v24 offset:96
    ds_read_b64_tr_b16 v[186:187], v24 offset:16992
    s_mov_b32 s3, 1040356334
    s_nop 3
    v_max3_f32 v46, v112, v113, v114
    v_max3_f32 v47, v116, v117, v118
    v_max3_f32 v46, v46, v115, v119
    v_max_f32 v46, v46, v47
    v_mov_b32 v47, v46
    s_nop 1
    v_permlane16_swap_b32 v46, v47
    v_max_f32 v46, v46, v47
    v_mov_b32 v47, v46
    s_nop 1
    v_permlane32_swap_b32 v46, v47
    v_max_f32 v46, v46, v47
    ds_write_b32 v25, v46
    v_mul_f32 v45, s3, v46
    v_fma_f32 v112, v112, s3, -v45
    v_fma_f32 v113, v113, s3, -v45
    v_fma_f32 v114, v114, s3, -v45
    v_fma_f32 v115, v115, s3, -v45
    v_fma_f32 v116, v116, s3, -v45
    v_fma_f32 v117, v117, s3, -v45
    v_fma_f32 v118, v118, s3, -v45
    v_fma_f32 v119, v119, s3, -v45
    s_waitcnt lgkmcnt(0)
    s_barrier
    ds_read_b128 v[28:31], v27
    ds_read_b64_tr_b16 v[188:189], v24 offset:33888
    ds_read_b64_tr_b16 v[190:191], v24 offset:50784
    v_exp_f32 v112, v112
    v_exp_f32 v113, v113
    v_exp_f32 v114, v114
    v_exp_f32 v115, v115
    v_exp_f32 v116, v116
    v_exp_f32 v117, v117
    v_exp_f32 v118, v118
    v_exp_f32 v119, v119
    s_waitcnt lgkmcnt(2)
    v_max3_f32 v46, v28, v29, v30
    v_max_f32 v46, v46, v31
    v_mul_f32 v44, s3, v46
    v_sub_f32 v45, v45, v44
    v_exp_f32 v45, v45
    s_nop 0
    v_mul_f32 v112, v112, v45
    v_mul_f32 v113, v113, v45
    v_mul_f32 v114, v114, v45
    v_mul_f32 v115, v115, v45
    v_mul_f32 v116, v116, v45
    v_mul_f32 v117, v117, v45
    v_mul_f32 v118, v118, v45
    v_mul_f32 v119, v119, v45
    v_cvt_pk_bf16_f32 v28, v112, v113
    v_cvt_pk_bf16_f32 v29, v114, v115
    v_cvt_pk_bf16_f32 v30, v116, v117
    v_cvt_pk_bf16_f32 v31, v118, v119
    ds_write_b128 v19, v[28:31]
    v_add_f32 v112, v112, v116
    v_add_f32 v113, v113, v117
    v_add_f32 v114, v114, v118
    v_add_f32 v115, v115, v119
    v_add_f32 v112, v112, v113
    v_add_f32 v114, v114, v115
    v_add_f32 v112, v112, v114
    ds_write_b32 v25, v112 offset:1024
    s_waitcnt lgkmcnt(0)
    s_barrier
    ds_read_b128 v[92:95], v20 offset:0
    ds_read_b128 v[96:99], v20 offset:1024
    ds_read_b128 v[100:103], v20 offset:2048
    ds_read_b128 v[104:107], v20 offset:3072
    ds_read_b128 v[112:115], v27 offset:1024
    s_waitcnt lgkmcnt(4)
    v_mfma_f32_16x16x32_bf16 v[48:51], v[128:131], v[92:95], 0
    s_waitcnt lgkmcnt(3)
    v_mfma_f32_16x16x32_bf16 v[48:51], v[132:135], v[96:99], v[48:51]
    s_waitcnt lgkmcnt(2)
    v_mfma_f32_16x16x32_bf16 v[48:51], v[136:139], v[100:103], v[48:51]
    s_waitcnt lgkmcnt(1)
    v_mfma_f32_16x16x32_bf16 v[48:51], v[140:143], v[104:107], v[48:51]
    v_mfma_f32_16x16x32_bf16 v[52:55], v[144:147], v[92:95], 0
    s_waitcnt lgkmcnt(0)
    v_add_f32 v45, v112, v113
    v_add_f32 v46, v114, v115
    v_add_f32 v45, v45, v46
    v_mfma_f32_16x16x32_bf16 v[52:55], v[148:151], v[96:99], v[52:55]
    v_mfma_f32_16x16x32_bf16 v[52:55], v[152:155], v[100:103], v[52:55]
    v_mov_b32 v46, v45
    s_nop 1
    v_permlane16_swap_b32 v45, v46
    v_add_f32 v45, v45, v46
    v_mov_b32 v46, v45
    s_nop 1
    v_permlane32_swap_b32 v45, v46
    v_add_f32 v45, v45, v46
    v_mov_b32 v46, v16
    v_mov_b32 v47, v17
    v_mfma_f32_16x16x32_bf16 v[52:55], v[156:159], v[104:107], v[52:55]
    v_mfma_f32_16x16x32_bf16 v[56:59], v[160:163], v[92:95], 0
    v_mfma_f32_16x16x32_bf16 v[56:59], v[164:167], v[96:99], v[56:59]
    v_cvt_pk_bf16_f32 v28, v48, v49
    v_cvt_pk_bf16_f32 v29, v50, v51
    v_mfma_f32_16x16x32_bf16 v[56:59], v[168:171], v[100:103], v[56:59]
    v_mfma_f32_16x16x32_bf16 v[56:59], v[172:175], v[104:107], v[56:59]
    s_nop 1
    v_cvt_pk_bf16_f32 v30, v52, v53
    v_cvt_pk_bf16_f32 v31, v54, v55
    v_mfma_f32_16x16x32_bf16 v[60:63], v[176:179], v[92:95], 0
    v_mfma_f32_16x16x32_bf16 v[60:63], v[180:183], v[96:99], v[60:63]
    v_permlane16_swap_b32 v28, v30
    v_permlane16_swap_b32 v29, v31
    buffer_store_dwordx4 v[28:31], v26, s[40:43], s60 offen offset:0 sc1
    v_mfma_f32_16x16x32_bf16 v[60:63], v[184:187], v[100:103], v[60:63]
    v_mfma_f32_16x16x32_bf16 v[60:63], v[188:191], v[104:107], v[60:63]
    v_cvt_pk_bf16_f32 v32, v56, v57
    v_cvt_pk_bf16_f32 v33, v58, v59
    s_nop 5
    v_cvt_pk_bf16_f32 v34, v60, v61
    v_cvt_pk_bf16_f32 v35, v62, v63
    s_nop 0
    v_permlane16_swap_b32 v32, v34
    v_permlane16_swap_b32 v33, v35
    buffer_store_dwordx4 v[32:35], v26, s[40:43], s60 offen offset:64 sc1
    s_barrier
    s_cmp_lg_u32 s31, 0
    s_cbranch_scc1 L_T_nost
    s_mov_b64 exec, 0xffff
    buffer_store_dwordx4 v[44:47], v7, s[40:43], s61 offen sc1
    s_mov_b64 exec, -1
L_T_nost:
    s_cmp_lg_u32 s31, 0
    s_cbranch_scc1 L_fin
    s_cmp_ge_u32 s6, 20
    s_cbranch_scc1 L_fin
    s_mul_i32 s3, s5, 10
    s_lshr_b32 s52, s6, 1
    s_add_u32 s3, s3, s52
    v_lshrrev_b32 v46, 3, v1
    v_mul_u32_u24 v25, 5120, v46
    v_and_b32 v46, 7, v1
    v_lshl_add_u32 v25, v46, 4, v25
    s_mul_i32 s52, s4, 327680
    s_lshl_b32 s53, s3, 7
    s_add_u32 s52, s52, s53
    s_add_u32 s52, s52, 786432
    s_add_u32 s53, s52, 40960
    s_add_u32 s54, s53, 40960
    s_add_u32 s55, s54, 40960
    s_add_u32 s56, s55, 40960
    s_add_u32 s57, s56, 40960
    s_add_u32 s58, s57, 40960
    s_add_u32 s59, s58, 40960
    s_mul_i32 s61, s4, 1280
    s_lshl_b32 s3, s3, 5
    s_add_u32 s61, s61, s3
    s_mov_b32 s44, s20
    s_mov_b32 s45, s21
    s_mov_b32 s46, 2560
    s_mov_b32 s47, 0x20000
    s_mov_b32 s48, s22
    s_mov_b32 s49, s23
    s_mov_b32 s50, 256
    s_mov_b32 s51, 0x20000
    s_lshl_b32 s67, s4, 5
    v_mov_b32 v26, 0
    v_lshlrev_b32 v27, 2, v1
    s_mov_b32 s33, 0x40000
L_R_non:
    buffer_load_dwordx4 v[28:31], v26, s[48:51], s67 offen offset:192 sc1
    buffer_load_dwordx4 v[32:35], v26, s[48:51], s67 offen offset:208 sc1
    s_waitcnt vmcnt(0)
    v_min_u32 v46, v28, v30
    v_min3_u32 v46, v46, v32, v34
    v_cmp_eq_u32 vcc, 0, v46
    s_cbranch_vccz L_R_non_ok
    s_sleep 8
    s_sub_u32 s33, s33, 1
    s_cbranch_scc0 L_R_non
L_R_non_ok:
    s_sleep 20
    s_mov_b32 s33, 0x40000
L_T_gc:
    buffer_load_dwordx4 v[52:55], v25, s[40:43], s52 offen sc1
    buffer_load_dwordx4 v[56:59], v25, s[40:43], s53 offen sc1
    buffer_load_dwordx4 v[60:63], v25, s[40:43], s54 offen sc1
    buffer_load_dwordx4 v[64:67], v25, s[40:43], s55 offen sc1
    buffer_load_dwordx4 v[68:71], v25, s[40:43], s56 offen sc1
    buffer_load_dwordx4 v[72:75], v25, s[40:43], s57 offen sc1
    buffer_load_dwordx4 v[76:79], v25, s[40:43], s58 offen sc1
    buffer_load_dwordx4 v[80:83], v25, s[40:43], s59 offen sc1
    s_waitcnt vmcnt(7)
    v_cmp_ne_u64 vcc, v[54:55], v[28:29]
    s_waitcnt vmcnt(6)
    v_cmp_ne_u64 s[62:63], v[58:59], v[28:29]
    v_add_f32 v56, v56, v52
    v_add_f32 v57, v57, v53
    s_or_b64 vcc, vcc, s[62:63]
    s_waitcnt vmcnt(5)
    v_cmp_ne_u64 s[62:63], v[62:63], v[30:31]
    s_nop 0
    s_or_b64 vcc, vcc, s[62:63]
    s_waitcnt vmcnt(4)
    v_cmp_ne_u64 s[62:63], v[66:67], v[30:31]
    v_add_f32 v64, v64, v60
    v_add_f32 v65, v65, v61
    s_or_b64 vcc, vcc, s[62:63]
    s_waitcnt vmcnt(3)
    v_cmp_ne_u64 s[62:63], v[70:71], v[32:33]
    s_nop 0
    s_or_b64 vcc, vcc, s[62:63]
    s_waitcnt vmcnt(2)
    v_cmp_ne_u64 s[62:63], v[74:75], v[32:33]
    v_add_f32 v72, v72, v68
    v_add_f32 v73, v73, v69
    s_or_b64 vcc, vcc, s[62:63]
    s_waitcnt vmcnt(1)
    v_cmp_ne_u64 s[62:63], v[78:79], v[34:35]
    s_nop 0
    s_or_b64 vcc, vcc, s[62:63]
    s_waitcnt vmcnt(0)
    v_cmp_ne_u64 s[62:63], v[82:83], v[34:35]
    v_add_f32 v80, v80, v76
    v_add_f32 v81, v81, v77
    s_or_b64 vcc, vcc, s[62:63]
    s_cbranch_vccz L_T_gc_ok
    s_sleep 2
    s_sub_u32 s33, s33, 1
    s_cbranch_scc0 L_T_gc
L_T_gc_ok:
    v_add_f32 v52, v56, v64
    v_add_f32 v53, v57, v65
    v_add_f32 v56, v72, v80
    v_add_f32 v57, v73, v81
    v_add_f32 v52, v52, v56
    v_add_f32 v53, v53, v57
    s_nop 0
    v_add_f32_dpp v52, v52, v52 row_ror:8 row_mask:0xf bank_mask:0xf
    v_add_f32_dpp v53, v53, v53 row_ror:8 row_mask:0xf bank_mask:0xf
    v_mov_b32 v56, v52
    v_mov_b32 v57, v53
    s_nop 0
    v_permlane16_swap_b32 v52, v56
    v_permlane16_swap_b32 v53, v57
    v_add_f32 v52, v52, v56
    v_add_f32 v53, v53, v57
    v_mov_b32 v56, v52
    v_mov_b32 v57, v53
    s_nop 0
    v_permlane32_swap_b32 v52, v56
    v_permlane32_swap_b32 v53, v57
    v_add_f32 v52, v52, v56
    v_add_f32 v53, v53, v57
    v_cvt_pk_bf16_f32 v52, v52, v53
    s_mov_b64 exec, 0xff
    buffer_store_dword v52, v27, s[44:47], s61 offen
L_fin:
    s_endpgm
L_PU:
    s_lshl_b32 s3, s65, 18
    s_add_u32 s3, s3, s38
    s_add_u32 s48, s14, s3
    s_addc_u32 s49, s15, 0
    s_sub_u32 s50, 4194304, s3
    s_mov_b32 s51, 0x20000
    v_lshlrev_b32 v5, 17, v4
    v_lshl_add_u32 v5, v44, 4, v5
    s_mov_b32 s66, 0
    s_lshl_b32 s3, s28, 1
    s_add_u32 s3, s3, s29
    s_mul_i32 s63, s3, 81920
    s_lshl_b32 s3, s31, 8
    s_add_u32 s63, s63, s3
    s_add_u32 s56, s18, s63
    s_addc_u32 s57, s19, 0
    s_sub_u32 s58, 5242880, s63
    s_mov_b32 s59, 0x20000
    v_lshrrev_b32 v47, 4, v1
    v_mul_u32_u24 v6, 20480, v47
    v_and_b32 v46, 15, v1
    v_lshl_add_u32 v6, v46, 4, v6
    s_mov_b32 s64, 0
    s_waitcnt vmcnt(6)
    v_perm_b32 v32, v52, v52, v16
    v_perm_b32 v33, v52, v52, v17
    v_perm_b32 v34, v52, v52, v18
    v_perm_b32 v35, v52, v52, v19
    s_waitcnt vmcnt(5)
    buffer_load_dwordx4 v[88:91], v2, s[44:47], s39 offen nt
    s_add_u32 s39, s39, 8192
    v_perm_b32 v36, v52, v52, v20
    v_perm_b32 v37, v52, v52, v21
    v_perm_b32 v38, v52, v52, v22
    v_perm_b32 v39, v52, v52, v23
    v_mfma_f32_16x16x32_bf16 v[40:43], v[32:35], v[64:67], 0
    s_waitcnt vmcnt(5)
    buffer_load_dwordx4 v[92:95], v2, s[44:47], s39 offen nt
    s_add_u32 s39, s39, 8192
    v_perm_b32 v32, v53, v53, v16
    v_perm_b32 v33, v53, v53, v17
    v_perm_b32 v34, v53, v53, v18
    v_perm_b32 v35, v53, v53, v19
    v_mfma_f32_16x16x32_bf16 v[40:43], v[36:39], v[68:71], v[40:43]
    s_waitcnt vmcnt(5)
    buffer_load_dwordx4 v[96:99], v2, s[44:47], s39 offen nt
    s_add_u32 s39, s39, 8192
    v_perm_b32 v36, v53, v53, v20
    v_perm_b32 v37, v53, v53, v21
    v_perm_b32 v38, v53, v53, v22
    v_perm_b32 v39, v53, v53, v23
    v_mfma_f32_16x16x32_bf16 v[40:43], v[32:35], v[72:75], v[40:43]
    s_waitcnt vmcnt(5)
    buffer_load_dwordx4 v[100:103], v2, s[44:47], s39 offen nt
    s_add_u32 s39, s39, 8192
    v_perm_b32 v32, v54, v54, v16
    v_perm_b32 v33, v54, v54, v17
    v_perm_b32 v34, v54, v54, v18
    v_perm_b32 v35, v54, v54, v19
    v_mfma_f32_16x16x32_bf16 v[40:43], v[36:39], v[76:79], v[40:43]
    s_waitcnt vmcnt(5)
    buffer_load_dwordx4 v[140:143], v5, s[48:51], s66 offen nt
    s_add_u32 s66, s66, 8192
    v_perm_b32 v36, v54, v54, v20
    v_perm_b32 v37, v54, v54, v21
    v_perm_b32 v38, v54, v54, v22
    v_perm_b32 v39, v54, v54, v23
    v_mfma_f32_16x16x32_bf16 v[40:43], v[32:35], v[80:83], v[40:43]
    s_waitcnt vmcnt(5)
    buffer_load_dwordx4 v[144:147], v5, s[48:51], s66 offen nt
    s_add_u32 s66, s66, 8192
    v_perm_b32 v32, v55, v55, v16
    v_perm_b32 v33, v55, v55, v17
    v_perm_b32 v34, v55, v55, v18
    v_perm_b32 v35, v55, v55, v19
    v_mfma_f32_16x16x32_bf16 v[40:43], v[36:39], v[84:87], v[40:43]
    s_waitcnt vmcnt(5)
    buffer_load_dwordx4 v[148:151], v5, s[48:51], s66 offen nt
    s_add_u32 s66, s66, 8192
    v_perm_b32 v36, v55, v55, v20
    v_perm_b32 v37, v55, v55, v21
    v_perm_b32 v38, v55, v55, v22
    v_perm_b32 v39, v55, v55, v23
    v_mfma_f32_16x16x32_bf16 v[40:43], v[32:35], v[88:91], v[40:43]
    s_waitcnt vmcnt(5)
    buffer_load_dwordx4 v[152:155], v5, s[48:51], s66 offen nt
    s_add_u32 s66, s66, 8192
    v_perm_b32 v32, v56, v56, v16
    v_perm_b32 v33, v56, v56, v17
    v_perm_b32 v34, v56, v56, v18
    v_perm_b32 v35, v56, v56, v19
    v_mfma_f32_16x16x32_bf16 v[40:43], v[36:39], v[92:95], v[40:43]
    s_waitcnt vmcnt(5)
    buffer_load_dwordx4 v[156:159], v5, s[48:51], s66 offen nt
    s_add_u32 s66, s66, 8192
    v_perm_b32 v36, v56, v56, v20
    v_perm_b32 v37, v56, v56, v21
    v_perm_b32 v38, v56, v56, v22
    v_perm_b32 v39, v56, v56, v23
    v_mfma_f32_16x16x32_bf16 v[40:43], v[32:35], v[96:99], v[40:43]
    s_waitcnt vmcnt(5)
    buffer_load_dwordx4 v[160:163], v5, s[48:51], s66 offen nt
    s_add_u32 s66, s66, 8192
    v_mfma_f32_16x16x32_bf16 v[40:43], v[36:39], v[100:103], v[40:43]
    s_nop 7
    ds_write_b128 v30, v[40:43]
    s_waitcnt lgkmcnt(0)
    s_barrier
    ds_read_b64 v[32:33], v31 offset:0
    ds_read_b64 v[34:35], v31 offset:1024
    ds_read_b64 v[36:37], v31 offset:2048
    ds_read_b64 v[38:39], v31 offset:3072
    ds_read_b64 v[42:43], v29
    s_waitcnt vmcnt(5)
    buffer_load_dwordx4 v[164:167], v5, s[48:51], s66 offen nt
    s_add_u32 s66, s66, 8192
    s_waitcnt lgkmcnt(0)
    v_add_f32 v32, v32, v34
    v_add_f32 v33, v33, v35
    v_add_f32 v36, v36, v38
    v_add_f32 v37, v37, v39
    v_add_f32 v40, v32, v36
    v_add_f32 v41, v33, v37
    s_mov_b32 exec_hi, 0
    buffer_store_dwordx4 v[40:43], v7, s[40:43], s62 offen sc1
    s_mov_b32 exec_hi, -1
    v_mov_b32 v26, v42
    v_mov_b32 v27, v43
    v_lshlrev_b32 v46, 5, v44
    v_add_u32 v46, 16384, v46
    v_and_b32 v2, 16, v1
    v_lshlrev_b32 v2, 7, v2
    v_lshl_add_u32 v2, v4, 6, v2
    v_and_b32 v3, 12, v1
    v_lshl_add_u32 v2, v3, 2, v2
    s_and_b32 s62, s26, 62
    s_lshl_b32 s62, s62, 4
    s_add_u32 s62, s62, s65
    s_lshl_b32 s62, s62, 7
    s_waitcnt vmcnt(5)
    buffer_load_dwordx4 v[168:171], v5, s[48:51], s66 offen nt
    s_add_u32 s66, s66, 8192
    s_waitcnt vmcnt(5)
    buffer_load_dwordx4 v[172:175], v5, s[48:51], s66 offen nt
    s_add_u32 s66, s66, 8192
    s_waitcnt vmcnt(5)
    buffer_load_dwordx4 v[176:179], v5, s[48:51], s66 offen nt
    s_add_u32 s66, s66, 8192
    s_waitcnt vmcnt(5)
    buffer_load_dwordx4 v[180:183], v5, s[48:51], s66 offen nt
    s_add_u32 s66, s66, 8192
    s_waitcnt vmcnt(5)
    buffer_load_dwordx4 v[184:187], v5, s[48:51], s66 offen nt
    s_add_u32 s66, s66, 8192
    s_barrier
    s_waitcnt vmcnt(5)
    buffer_load_dwordx4 v[188:191], v5, s[48:51], s66 offen nt
    s_add_u32 s66, s66, 8192
    s_waitcnt vmcnt(5)
    buffer_load_dwordx4 v[192:195], v5, s[48:51], s66 offen nt
    s_add_u32 s66, s66, 8192
    s_waitcnt vmcnt(5)
    buffer_load_dwordx4 v[196:199], v5, s[48:51], s66 offen nt
    s_add_u32 s66, s66, 8192
    s_waitcnt vmcnt(5)
    buffer_load_dwordx4 v[200:203], v5, s[48:51], s66 offen nt
    s_barrier
    ds_read_b128 v[60:63], v46 offset:0
    ds_read_b128 v[64:67], v46 offset:16
    ds_read_b128 v[68:71], v46 offset:1024
    ds_read_b128 v[72:75], v46 offset:1040
    ds_read_b128 v[76:79], v46 offset:2048
    ds_read_b128 v[80:83], v46 offset:2064
    ds_read_b128 v[84:87], v46 offset:3072
    ds_read_b128 v[88:91], v46 offset:3088
    s_waitcnt lgkmcnt(0)
    v_add_f32 v60, v60, v68
    v_add_f32 v61, v61, v69
    v_add_f32 v62, v62, v70
    v_add_f32 v63, v63, v71
    v_add_f32 v64, v64, v72
    v_add_f32 v65, v65, v73
    v_add_f32 v66, v66, v74
    v_add_f32 v67, v67, v75
    v_add_f32 v76, v76, v84
    v_add_f32 v77, v77, v85
    v_add_f32 v78, v78, v86
    v_add_f32 v79, v79, v87
    v_add_f32 v80, v80, v88
    v_add_f32 v81, v81, v89
    v_add_f32 v82, v82, v90
    v_add_f32 v83, v83, v91
    v_add_f32 v48, v60, v76
    v_add_f32 v49, v61, v77
    v_add_f32 v50, v62, v78
    v_add_f32 v51, v63, v79
    v_add_f32 v52, v64, v80
    v_add_f32 v53, v65, v81
    v_add_f32 v54, v66, v82
    v_add_f32 v55, v67, v83
    v_cvt_pk_bf16_f32 v56, v48, v49
    v_cvt_pk_bf16_f32 v57, v50, v51
    v_cvt_pk_bf16_f32 v58, v52, v53
    v_cvt_pk_bf16_f32 v59, v54, v55
    v_dot2_f32_bf16 v60, v140, v56, 0
    v_dot2_f32_bf16 v61, v144, v56, 0
    v_dot2_f32_bf16 v62, v148, v56, 0
    v_dot2_f32_bf16 v63, v152, v56, 0
    v_dot2_f32_bf16 v64, v156, v56, 0
    v_dot2_f32_bf16 v65, v160, v56, 0
    v_dot2_f32_bf16 v66, v164, v56, 0
    v_dot2_f32_bf16 v67, v168, v56, 0
    v_dot2c_f32_bf16 v60, v141, v57
    v_dot2c_f32_bf16 v61, v145, v57
    v_dot2c_f32_bf16 v62, v149, v57
    v_dot2c_f32_bf16 v63, v153, v57
    v_dot2c_f32_bf16 v64, v157, v57
    v_dot2c_f32_bf16 v65, v161, v57
    v_dot2c_f32_bf16 v66, v165, v57
    v_dot2c_f32_bf16 v67, v169, v57
    v_dot2c_f32_bf16 v60, v142, v58
    v_dot2c_f32_bf16 v61, v146, v58
    v_dot2c_f32_bf16 v62, v150, v58
    v_dot2c_f32_bf16 v63, v154, v58
    v_dot2c_f32_bf16 v64, v158, v58
    v_dot2c_f32_bf16 v65, v162, v58
    v_dot2c_f32_bf16 v66, v166, v58
    v_dot2c_f32_bf16 v67, v170, v58
    v_dot2c_f32_bf16 v60, v143, v59
    v_dot2c_f32_bf16 v61, v147, v59
    v_dot2c_f32_bf16 v62, v151, v59
    v_dot2c_f32_bf16 v63, v155, v59
    v_dot2c_f32_bf16 v64, v159, v59
    v_dot2c_f32_bf16 v65, v163, v59
    v_dot2c_f32_bf16 v66, v167, v59
    v_dot2c_f32_bf16 v67, v171, v59
    v_add_f32_dpp v60, v60, v60 row_ror:8 row_mask:0xf bank_mask:0x3
    v_add_f32_dpp v61, v61, v61 row_ror:8 row_mask:0xf bank_mask:0x3
    v_add_f32_dpp v62, v62, v62 row_ror:8 row_mask:0xf bank_mask:0x3
    v_add_f32_dpp v63, v63, v63 row_ror:8 row_mask:0xf bank_mask:0x3
    v_add_f32_dpp v64, v64, v64 row_ror:8 row_mask:0xf bank_mask:0x3
    v_add_f32_dpp v65, v65, v65 row_ror:8 row_mask:0xf bank_mask:0x3
    v_add_f32_dpp v66, v66, v66 row_ror:8 row_mask:0xf bank_mask:0x3
    v_add_f32_dpp v67, v67, v67 row_ror:8 row_mask:0xf bank_mask:0x3
    s_waitcnt vmcnt(0)
    v_dot2_f32_bf16 v68, v172, v56, 0
    v_dot2_f32_bf16 v69, v176, v56, 0
    v_dot2_f32_bf16 v70, v180, v56, 0
    v_dot2_f32_bf16 v71, v184, v56, 0
    v_dot2_f32_bf16 v72, v188, v56, 0
    v_dot2_f32_bf16 v73, v192, v56, 0
    v_dot2_f32_bf16 v74, v196, v56, 0
    v_dot2_f32_bf16 v75, v200, v56, 0
    v_dot2c_f32_bf16 v68, v173, v57
    v_dot2c_f32_bf16 v69, v177, v57
    v_dot2c_f32_bf16 v70, v181, v57
    v_dot2c_f32_bf16 v71, v185, v57
    v_dot2c_f32_bf16 v72, v189, v57
    v_dot2c_f32_bf16 v73, v193, v57
    v_dot2c_f32_bf16 v74, v197, v57
    v_dot2c_f32_bf16 v75, v201, v57
    v_dot2c_f32_bf16 v68, v174, v58
    v_dot2c_f32_bf16 v69, v178, v58
    v_dot2c_f32_bf16 v70, v182, v58
    v_dot2c_f32_bf16 v71, v186, v58
    v_dot2c_f32_bf16 v72, v190, v58
    v_dot2c_f32_bf16 v73, v194, v58
    v_dot2c_f32_bf16 v74, v198, v58
    v_dot2c_f32_bf16 v75, v202, v58
    v_dot2c_f32_bf16 v68, v175, v59
    v_dot2c_f32_bf16 v69, v179, v59
    v_dot2c_f32_bf16 v70, v183, v59
    v_dot2c_f32_bf16 v71, v187, v59
    v_dot2c_f32_bf16 v72, v191, v59
    v_dot2c_f32_bf16 v73, v195, v59
    v_dot2c_f32_bf16 v74, v199, v59
    v_dot2c_f32_bf16 v75, v203, v59
    v_add_f32_dpp v60, v68, v68 row_ror:8 row_mask:0xf bank_mask:0xc
    v_add_f32_dpp v61, v69, v69 row_ror:8 row_mask:0xf bank_mask:0xc
    v_add_f32_dpp v62, v70, v70 row_ror:8 row_mask:0xf bank_mask:0xc
    v_add_f32_dpp v63, v71, v71 row_ror:8 row_mask:0xf bank_mask:0xc
    v_add_f32_dpp v64, v72, v72 row_ror:8 row_mask:0xf bank_mask:0xc
    v_add_f32_dpp v65, v73, v73 row_ror:8 row_mask:0xf bank_mask:0xc
    v_add_f32_dpp v66, v74, v74 row_ror:8 row_mask:0xf bank_mask:0xc
    v_add_f32_dpp v67, v75, v75 row_ror:8 row_mask:0xf bank_mask:0xc
    v_add_f32_dpp v60, v60, v60 row_half_mirror row_mask:0xf bank_mask:0x5
    v_add_f32_dpp v61, v61, v61 row_half_mirror row_mask:0xf bank_mask:0x5
    v_add_f32_dpp v62, v62, v62 row_half_mirror row_mask:0xf bank_mask:0x5
    v_add_f32_dpp v63, v63, v63 row_half_mirror row_mask:0xf bank_mask:0x5
    v_add_f32_dpp v60, v64, v64 row_half_mirror row_mask:0xf bank_mask:0xa
    v_add_f32_dpp v61, v65, v65 row_half_mirror row_mask:0xf bank_mask:0xa
    v_add_f32_dpp v62, v66, v66 row_half_mirror row_mask:0xf bank_mask:0xa
    v_add_f32_dpp v63, v67, v67 row_half_mirror row_mask:0xf bank_mask:0xa
    v_add_f32_dpp v60, v60, v60 quad_perm:[2,3,0,1] row_mask:0xf bank_mask:0xf
    v_add_f32_dpp v61, v61, v61 quad_perm:[2,3,0,1] row_mask:0xf bank_mask:0xf
    v_add_f32_dpp v62, v62, v62 quad_perm:[2,3,0,1] row_mask:0xf bank_mask:0xf
    v_add_f32_dpp v63, v63, v63 quad_perm:[2,3,0,1] row_mask:0xf bank_mask:0xf
    v_add_f32_dpp v60, v60, v60 quad_perm:[1,0,3,2] row_mask:0xf bank_mask:0xf
    v_add_f32_dpp v61, v61, v61 quad_perm:[1,0,3,2] row_mask:0xf bank_mask:0xf
    v_add_f32_dpp v62, v62, v62 quad_perm:[1,0,3,2] row_mask:0xf bank_mask:0xf
    v_add_f32_dpp v63, v63, v63 quad_perm:[1,0,3,2] row_mask:0xf bank_mask:0xf
    v_cvt_pk_bf16_f32 v24, v60, v61
    v_cvt_pk_bf16_f32 v25, v62, v63
    s_mov_b32 exec_lo, 0x11111111
    s_mov_b32 exec_hi, 0x11111111
    buffer_store_dwordx4 v[24:27], v2, s[40:43], s62 offen sc1
    s_mov_b64 exec, -1
    v_lshlrev_b32 v44, 2, v1
    v_add_u32 v44, 20480, v44
    s_lshl_b32 s3, s31, 7
    s_add_u32 s3, s3, 0
    v_lshl_add_u32 v46, v1, 1, s3
    v_lshrrev_b32 v47, 4, v1
    v_lshl_add_u32 v47, v47, 5, s3
    v_and_b32 v45, 15, v1
    v_lshlrev_b32 v45, 6, v45
    v_and_b32 v48, 16, v1
    v_lshl_add_u32 v45, v48, 1, v45
    v_lshrrev_b32 v48, 5, v1
    v_lshl_add_u32 v45, v48, 4, v45
    s_lshl_b32 s62, s26, 1
    s_add_u32 s62, s62, s29
    s_mul_i32 s62, s62, 5
    s_add_u32 s62, s62, s31
    s_lshl_b32 s62, s62, 10
    s_add_u32 s62, s62, 786432
    s_sleep 12
    buffer_load_dwordx4 v[96:99], v6, s[56:59], s64 offen offset:0 nt
    buffer_load_dwordx4 v[100:103], v6, s[56:59], s64 offen offset:1280 nt
    buffer_load_dwordx4 v[104:107], v6, s[56:59], s64 offen offset:2560 nt
    s_add_u32 s64, s64, 3840
    s_waitcnt vmcnt(3)
    buffer_load_dwordx4 v[108:111], v6, s[56:59], s64 offen offset:0 nt
    s_waitcnt vmcnt(3)
    buffer_load_dwordx4 v[112:115], v6, s[56:59], s64 offen offset:1280 nt
    s_waitcnt vmcnt(3)
    buffer_load_dwordx4 v[116:119], v6, s[56:59], s64 offen offset:2560 nt
    s_add_u32 s64, s64, 3840
    s_waitcnt vmcnt(3)
    buffer_load_dwordx4 v[120:123], v6, s[56:59], s64 offen offset:0 nt
    s_waitcnt vmcnt(3)
    buffer_load_dwordx4 v[124:127], v6, s[56:59], s64 offen offset:1280 nt
    s_waitcnt vmcnt(3)
    buffer_load_dwordx4 v[128:131], v6, s[56:59], s64 offen offset:2560 nt
    s_add_u32 s64, s64, 3840
    s_waitcnt vmcnt(3)
    buffer_load_dwordx4 v[132:135], v6, s[56:59], s64 offen offset:0 nt
    s_waitcnt vmcnt(3)
    buffer_load_dwordx4 v[136:139], v6, s[56:59], s64 offen offset:1280 nt
    s_waitcnt vmcnt(3)
    buffer_load_dwordx4 v[204:207], v6, s[56:59], s64 offen offset:2560 nt
    s_add_u32 s64, s64, 3840
    s_waitcnt vmcnt(3)
    buffer_load_dwordx4 v[208:211], v6, s[56:59], s64 offen offset:0 nt
    s_waitcnt vmcnt(3)
    buffer_load_dwordx4 v[212:215], v6, s[56:59], s64 offen offset:1280 nt
    s_waitcnt vmcnt(3)
    buffer_load_dwordx4 v[216:219], v6, s[56:59], s64 offen offset:2560 nt
    s_add_u32 s64, s64, 3840
    s_waitcnt vmcnt(3)
    buffer_load_dwordx4 v[220:223], v6, s[56:59], s64 offen offset:0 nt
    s_barrier
    ds_read_b32 v80, v44 offset:0
    ds_read_b32 v81, v44 offset:256
    ds_read_b32 v82, v44 offset:512
    ds_read_b32 v83, v44 offset:768
    s_waitcnt lgkmcnt(0)
    v_add_f32 v80, v80, v81
    v_add_f32 v82, v82, v83
    v_add_f32 v80, v80, v82
    v_cvt_pk_bf16_f32 v80, v80, v80
    ds_write_b16 v46, v80
    ds_read_b128 v[56:59], v47
    ds_read_b128 v[60:63], v47 offset:16
    s_waitcnt lgkmcnt(0)
    v_perm_b32 v64, v56, v56, v8
    v_perm_b32 v65, v56, v56, v9
    v_perm_b32 v66, v56, v56, v10
    v_perm_b32 v67, v56, v56, v11
    v_perm_b32 v68, v56, v56, v12
    v_perm_b32 v69, v56, v56, v13
    v_perm_b32 v70, v56, v56, v14
    v_perm_b32 v71, v56, v56, v15
    v_mfma_f32_16x16x32_bf16 v[72:75], v[64:67], v[96:99], 0
    v_perm_b32 v64, v57, v57, v8
    v_perm_b32 v65, v57, v57, v9
    v_perm_b32 v66, v57, v57, v10
    v_perm_b32 v67, v57, v57, v11
    v_mfma_f32_16x16x32_bf16 v[72:75], v[68:71], v[100:103], v[72:75]
    v_perm_b32 v68, v57, v57, v12
    v_perm_b32 v69, v57, v57, v13
    v_perm_b32 v70, v57, v57, v14
    v_perm_b32 v71, v57, v57, v15
    v_mfma_f32_16x16x32_bf16 v[72:75], v[64:67], v[104:107], v[72:75]
    v_perm_b32 v64, v58, v58, v8
    v_perm_b32 v65, v58, v58, v9
    v_perm_b32 v66, v58, v58, v10
    v_perm_b32 v67, v58, v58, v11
    v_mfma_f32_16x16x32_bf16 v[72:75], v[68:71], v[108:111], v[72:75]
    v_perm_b32 v68, v58, v58, v12
    v_perm_b32 v69, v58, v58, v13
    v_perm_b32 v70, v58, v58, v14
    v_perm_b32 v71, v58, v58, v15
    v_mfma_f32_16x16x32_bf16 v[72:75], v[64:67], v[112:115], v[72:75]
    v_perm_b32 v64, v59, v59, v8
    v_perm_b32 v65, v59, v59, v9
    v_perm_b32 v66, v59, v59, v10
    v_perm_b32 v67, v59, v59, v11
    v_mfma_f32_16x16x32_bf16 v[72:75], v[68:71], v[116:119], v[72:75]
    v_perm_b32 v68, v59, v59, v12
    v_perm_b32 v69, v59, v59, v13
    v_perm_b32 v70, v59, v59, v14
    v_perm_b32 v71, v59, v59, v15
    v_mfma_f32_16x16x32_bf16 v[72:75], v[64:67], v[120:123], v[72:75]
    v_perm_b32 v64, v60, v60, v8
    v_perm_b32 v65, v60, v60, v9
    v_perm_b32 v66, v60, v60, v10
    v_perm_b32 v67, v60, v60, v11
    v_mfma_f32_16x16x32_bf16 v[72:75], v[68:71], v[124:127], v[72:75]
    v_perm_b32 v68, v60, v60, v12
    v_perm_b32 v69, v60, v60, v13
    v_perm_b32 v70, v60, v60, v14
    v_perm_b32 v71, v60, v60, v15
    v_mfma_f32_16x16x32_bf16 v[72:75], v[64:67], v[128:131], v[72:75]
    v_perm_b32 v64, v61, v61, v8
    v_perm_b32 v65, v61, v61, v9
    v_perm_b32 v66, v61, v61, v10
    v_perm_b32 v67, v61, v61, v11
    v_mfma_f32_16x16x32_bf16 v[72:75], v[68:71], v[132:135], v[72:75]
    v_perm_b32 v68, v61, v61, v12
    v_perm_b32 v69, v61, v61, v13
    v_perm_b32 v70, v61, v61, v14
    v_perm_b32 v71, v61, v61, v15
    v_mfma_f32_16x16x32_bf16 v[72:75], v[64:67], v[136:139], v[72:75]
    v_perm_b32 v64, v62, v62, v8
    v_perm_b32 v65, v62, v62, v9
    v_perm_b32 v66, v62, v62, v10
    v_perm_b32 v67, v62, v62, v11
    v_mfma_f32_16x16x32_bf16 v[72:75], v[68:71], v[204:207], v[72:75]
    v_perm_b32 v68, v62, v62, v12
    v_perm_b32 v69, v62, v62, v13
    v_perm_b32 v70, v62, v62, v14
    v_perm_b32 v71, v62, v62, v15
    s_waitcnt vmcnt(3)
    v_mfma_f32_16x16x32_bf16 v[72:75], v[64:67], v[208:211], v[72:75]
    v_perm_b32 v64, v63, v63, v8
    v_perm_b32 v65, v63, v63, v9
    v_perm_b32 v66, v63, v63, v10
    v_perm_b32 v67, v63, v63, v11
    s_waitcnt vmcnt(2)
    v_mfma_f32_16x16x32_bf16 v[72:75], v[68:71], v[212:215], v[72:75]
    v_perm_b32 v68, v63, v63, v12
    v_perm_b32 v69, v63, v63, v13
    v_perm_b32 v70, v63, v63, v14
    v_perm_b32 v71, v63, v63, v15
    s_waitcnt vmcnt(1)
    v_mfma_f32_16x16x32_bf16 v[72:75], v[64:67], v[216:219], v[72:75]
    s_waitcnt vmcnt(0)
    v_mfma_f32_16x16x32_bf16 v[72:75], v[68:71], v[220:223], v[72:75]
    s_nop 7
    v_mov_b32 v24, v72
    v_mov_b32 v25, v73
    v_mov_b32_dpp v24, v74 quad_perm:[0,1,2,3] row_mask:0xc bank_mask:0xf
    v_mov_b32_dpp v25, v75 quad_perm:[0,1,2,3] row_mask:0xc bank_mask:0xf
    buffer_store_dwordx4 v[24:27], v45, s[40:43], s62 offen sc1
    s_endpgm
L_S:
    s_sub_u32 s31, s31, 4
    v_mov_b32 v16, -1
    v_mov_b32 v17, -1
    v_mov_b32 v18, -1
    v_mov_b32 v19, -1
    v_mov_b32 v44, 0
    v_mov_b32 v39, 160256
    s_lshl_b32 s67, s4, 5
    s_waitcnt lgkmcnt(0)
    s_mov_b32 s40, s24
    s_mov_b32 s41, s25
    s_mov_b32 s42, 4194304
    s_mov_b32 s43, 0x20000
    s_mov_b32 s48, s22
    s_mov_b32 s49, s23
    s_mov_b32 s50, 256
    s_mov_b32 s51, 0x20000
    s_cmp_lg_u32 s31, 0
    s_cbranch_scc1 L_S_w123
    s_and_b32 s52, s2, 7
    s_lshl_b32 s52, s52, 3
    s_cmp_lg_u32 s6, 0
    s_cbranch_scc1 L_S_nolead
    s_memrealtime s[54:55]
    v_lshlrev_b32 v45, 6, v1
    s_waitcnt lgkmcnt(0)
    s_or_b32 s54, s54, 1
    v_mov_b32 v46, s54
    v_mov_b32 v47, s55
    s_mov_b64 exec, 15
    buffer_store_dwordx2 v[46:47], v45, s[48:51], s52 offen sc1
    s_mov_b64 exec, -1
    s_branch L_S_np_ok
L_S_nolead:
    s_sleep 14
    s_add_u32 s34, s22, s52
    s_addc_u32 s35, s23, 0
    s_load_dwordx2 s[54:55], s[34:35], 0
    s_waitcnt lgkmcnt(0)
    s_cmp_lg_u32 s54, 0
    s_cbranch_scc1 L_S_np_ok
    s_sleep 8
    s_load_dwordx2 s[54:55], s[34:35], 64
    s_waitcnt lgkmcnt(0)
    s_cmp_lg_u32 s54, 0
    s_cbranch_scc1 L_S_np_ok
    s_sleep 8
    s_load_dwordx2 s[54:55], s[34:35], 128
    s_waitcnt lgkmcnt(0)
    s_cmp_lg_u32 s54, 0
    s_cbranch_scc1 L_S_np_ok
    s_sleep 8
    s_load_dwordx2 s[54:55], s[34:35], 192
    s_waitcnt lgkmcnt(0)
    s_cmp_lg_u32 s54, 0
    s_cbranch_scc1 L_S_np_ok
    s_sleep 8
    s_mov_b32 s33, 0x40000
    v_mov_b32 v46, 0
L_S_np:
    buffer_load_dwordx2 v[48:49], v46, s[48:51], s52 offen offset:192 sc1
    s_waitcnt vmcnt(0)
    v_readfirstlane_b32 s54, v48
    v_readfirstlane_b32 s55, v49
    s_cmp_lg_u32 s54, 0
    s_cbranch_scc1 L_S_np_ok
    s_sleep 16
    s_sub_u32 s33, s33, 1
    s_cbranch_scc0 L_S_np
L_S_np_ok:
    v_mov_b32 v46, s54
    v_mov_b32 v47, s55
    ds_write_b64 v39, v[46:47]
    ds_write_b32 v39, v44 offset:8
    s_waitcnt lgkmcnt(0)
L_S_w123:
    s_cmp_lg_u32 s31, 2
    s_cbranch_scc1 L_S_npf
    s_getpc_b64 s[34:35]
L_pc:
    s_sub_u32 s34, s34, L_pc-concat_heads__compressed_kv_cla__compressed_kv_cla__decode_kernel
    s_subb_u32 s35, s35, 0
    s_and_b32 s3, s6, 15
    s_lshl_b32 s3, s3, 10
    v_add_u32 v46, s3, v7
    global_load_dwordx4 v[200:203], v46, s[34:35]
L_S_npf:
    s_cmp_eq_u32 s30, 0
    s_cbranch_scc1 L_SU
    s_lshl_b32 s68, s31, 1
    s_lshl_b32 s60, s4, 1
    s_add_u32 s60, s60, s29
    s_lshl_b32 s61, s60, 5
    s_add_u32 s61, s61, s28
    s_lshl_b32 s61, s61, 8
    s_add_u32 s61, s61, 1572864
    s_lshl_b32 s60, s60, 9
    s_add_u32 s60, s60, s28
    s_lshl_b32 s60, s60, 3
    s_add_u32 s60, s60, s68
    s_lshl_b32 s60, s60, 7
    s_add_u32 s60, s60, 2097152
    v_lshrrev_b32 v38, 4, v1
    v_lshlrev_b32 v38, 15, v38
    v_and_b32 v37, 15, v1
    v_lshl_add_u32 v38, v37, 4, v38
    s_barrier
    s_mov_b32 s62, s60
    s_lshl_b32 s68, s31, 1
    s_add_u32 s68, s68, 1
    s_lshl_b32 s60, s4, 1
    s_add_u32 s60, s60, s29
    s_lshl_b32 s61, s60, 5
    s_add_u32 s61, s61, s28
    s_lshl_b32 s61, s61, 8
    s_add_u32 s61, s61, 1572864
    s_lshl_b32 s60, s60, 9
    s_add_u32 s60, s60, s28
    s_lshl_b32 s60, s60, 3
    s_add_u32 s60, s60, s68
    s_lshl_b32 s60, s60, 7
    s_add_u32 s60, s60, 2097152
    v_and_b32 v46, 15, v1
    v_lshrrev_b32 v44, 2, v1
    v_mul_u32_u24 v23, 1056, v44
    v_and_b32 v44, 3, v1
    v_lshl_add_u32 v23, v44, 3, v23
    s_lshl_b32 s3, s68, 7
    v_add_u32 v23, s3, v23
    v_add_u32 v24, 67584, v23
    v_lshlrev_b32 v26, 15, v46
    v_and_b32 v44, 16, v1
    v_lshl_add_u32 v26, v44, 1, v26
    v_lshrrev_b32 v44, 5, v1
    v_lshl_add_u32 v26, v44, 4, v26
    v_add_u32 v27, 152064, v7
    v_add_u32 v20, 156160, v7
    s_waitcnt vmcnt(0)
    s_lshl_b32 s52, s29, 1
    s_lshr_b32 s3, s31, 1
    s_add_u32 s52, s52, s3
    s_lshl_b32 s52, s52, 3
    s_add_u32 s52, s52, s67
    s_add_u32 s34, s22, s52
    s_addc_u32 s35, s23, 0
    s_load_dwordx2 s[54:55], s[34:35], 192
    s_waitcnt lgkmcnt(0)
    s_cmp_lg_u32 s54, 0
    s_cbranch_scc1 L_T_np_ok
    s_sleep 8
    s_mov_b32 s33, 0x40000
    v_mov_b32 v46, 0
L_T_np:
    buffer_load_dwordx2 v[48:49], v46, s[48:51], s52 offen offset:192 sc1
    s_waitcnt vmcnt(0)
    v_readfirstlane_b32 s54, v48
    v_readfirstlane_b32 s55, v49
    s_cmp_lg_u32 s54, 0
    s_cbranch_scc1 L_T_np_ok
    s_sleep 16
    s_sub_u32 s33, s33, 1
    s_cbranch_scc0 L_T_np
L_T_np_ok:
    s_lshl_b32 s52, s4, 1
    s_add_u32 s52, s52, s29
    s_lshl_b32 s52, s52, 2
    s_add_u32 s52, s52, s31
    s_lshl_b32 s52, s52, 13
    s_add_u32 s53, s52, 4096
    s_mul_i32 s3, s31, 4224
    s_add_u32 s3, s3, 135168
    v_lshl_add_u32 v25, v1, 3, s3
    s_lshr_b32 s3, s6, 4
    s_lshl_b32 s3, s3, 10
    s_lshl_b32 s36, s5, 11
    s_add_u32 s3, s3, s36
    s_add_u32 s3, s3, 384
    s_lshl_b32 s36, s31, 20
    s_add_u32 s3, s3, s36
    s_add_u32 s48, s16, s3
    s_addc_u32 s49, s17, 0
    s_sub_u32 s50, 4194304, s3
    s_mov_b32 s51, 0x20000
    s_bfe_u32 s3, s6, 0x30001
    s_sub_u32 s69, 15, s3
    s_lshl_b32 s69, s69, 13
    v_lshrrev_b32 v10, 3, v1
    v_lshlrev_b32 v10, 17, v10
    v_and_b32 v8, 7, v1
    v_lshl_add_u32 v10, v8, 4, v10
    s_barrier
    v_and_b32 v37, 15, v1
    v_lshlrev_b32 v37, 7, v37
    v_and_b32 v36, 16, v1
    v_lshl_add_u32 v37, v36, 8, v37
    s_mov_b32 s33, 0x40000
L_T_ga:
    buffer_load_dwordx4 v[48:51], v7, s[40:43], s52 offen offset:0 sc1
    buffer_load_dwordx4 v[52:55], v7, s[40:43], s52 offen offset:1024 sc1
    buffer_load_dwordx4 v[56:59], v7, s[40:43], s52 offen offset:2048 sc1
    buffer_load_dwordx4 v[60:63], v7, s[40:43], s52 offen offset:3072 sc1
    buffer_load_dwordx4 v[64:67], v7, s[40:43], s53 offen offset:0 sc1
    buffer_load_dwordx4 v[68:71], v7, s[40:43], s53 offen offset:1024 sc1
    buffer_load_dwordx4 v[72:75], v7, s[40:43], s53 offen offset:2048 sc1
    buffer_load_dwordx4 v[76:79], v7, s[40:43], s53 offen offset:3072 sc1
    s_waitcnt vmcnt(7)
    ds_write_b64 v25, v[48:49] offset:0
    v_cmp_ne_u64 vcc, s[54:55], v[50:51]
    s_waitcnt vmcnt(6)
    ds_write_b64 v25, v[52:53] offset:512
    v_cmp_ne_u64 s[70:71], s[54:55], v[54:55]
    s_nop 0
    s_or_b64 vcc, vcc, s[70:71]
    s_waitcnt vmcnt(5)
    ds_write_b64 v25, v[56:57] offset:1056
    v_cmp_ne_u64 s[70:71], s[54:55], v[58:59]
    s_nop 0
    s_or_b64 vcc, vcc, s[70:71]
    s_waitcnt vmcnt(4)
    ds_write_b64 v25, v[60:61] offset:1568
    v_cmp_ne_u64 s[70:71], s[54:55], v[62:63]
    s_nop 0
    s_or_b64 vcc, vcc, s[70:71]
    s_waitcnt vmcnt(3)
    ds_write_b64 v25, v[64:65] offset:2112
    v_cmp_ne_u64 s[70:71], s[54:55], v[66:67]
    s_nop 0
    s_or_b64 vcc, vcc, s[70:71]
    s_waitcnt vmcnt(2)
    ds_write_b64 v25, v[68:69] offset:2624
    v_cmp_ne_u64 s[70:71], s[54:55], v[70:71]
    s_nop 0
    s_or_b64 vcc, vcc, s[70:71]
    s_waitcnt vmcnt(1)
    ds_write_b64 v25, v[72:73] offset:3168
    v_cmp_ne_u64 s[70:71], s[54:55], v[74:75]
    s_nop 0
    s_or_b64 vcc, vcc, s[70:71]
    s_waitcnt vmcnt(0)
    ds_write_b64 v25, v[76:77] offset:3680
    v_cmp_ne_u64 s[70:71], s[54:55], v[78:79]
    s_nop 0
    s_or_b64 vcc, vcc, s[70:71]
    s_cbranch_vccz L_T_ga_ok
L_T_ha:
    s_sleep 3
L_T_ha0:
    buffer_load_dwordx2 v[48:49], v37, s[40:43], s52 offen offset:8 sc1
    s_waitcnt vmcnt(0)
    s_sub_u32 s33, s33, 1
    s_cbranch_scc1 L_T_ga_ok
    v_cmp_ne_u64 vcc, s[54:55], v[48:49]
    s_cbranch_vccnz L_T_ha
    s_branch L_T_ga
L_T_ga_ok:
    buffer_store_dwordx4 v[16:19], v38, s[40:43], s62 offen sc1
    s_add_u32 s62, s62, 131072
    buffer_store_dwordx4 v[16:19], v38, s[40:43], s62 offen sc1
    s_add_u32 s62, s62, 131072
    buffer_store_dwordx4 v[16:19], v38, s[40:43], s62 offen sc1
    s_add_u32 s62, s62, 131072
    buffer_store_dwordx4 v[16:19], v38, s[40:43], s62 offen sc1
    s_waitcnt lgkmcnt(0)
    s_barrier
    buffer_load_dwordx4 v[124:127], v10, s[48:51], s69 offen
    s_barrier
    ds_read_b64_tr_b16 v[128:129], v23 offset:0
    ds_read_b64_tr_b16 v[130:131], v23 offset:16896
    ds_read_b64_tr_b16 v[132:133], v23 offset:33792
    ds_read_b64_tr_b16 v[134:135], v23 offset:50688
    ds_read_b64_tr_b16 v[136:137], v24 offset:0
    ds_read_b64_tr_b16 v[138:139], v24 offset:16896
    ds_read_b64_tr_b16 v[140:141], v24 offset:33792
    ds_read_b64_tr_b16 v[142:143], v24 offset:50688
    ds_read_b64_tr_b16 v[144:145], v23 offset:32
    ds_read_b64_tr_b16 v[146:147], v23 offset:16928
    ds_read_b64_tr_b16 v[148:149], v23 offset:33824
    ds_read_b64_tr_b16 v[150:151], v23 offset:50720
    ds_read_b64_tr_b16 v[152:153], v24 offset:32
    ds_read_b64_tr_b16 v[154:155], v24 offset:16928
    ds_read_b64_tr_b16 v[156:157], v24 offset:33824
    ds_read_b64_tr_b16 v[158:159], v24 offset:50720
    ds_read_b64_tr_b16 v[160:161], v23 offset:64
    ds_read_b64_tr_b16 v[162:163], v23 offset:16960
    ds_read_b64_tr_b16 v[164:165], v23 offset:33856
    ds_read_b64_tr_b16 v[166:167], v23 offset:50752
    ds_read_b64_tr_b16 v[168:169], v24 offset:64
    ds_read_b64_tr_b16 v[170:171], v24 offset:16960
    ds_read_b64_tr_b16 v[172:173], v24 offset:33856
    ds_read_b64_tr_b16 v[174:175], v24 offset:50752
    ds_read_b64_tr_b16 v[176:177], v23 offset:96
    ds_read_b64_tr_b16 v[178:179], v23 offset:16992
    ds_read_b64_tr_b16 v[180:181], v23 offset:33888
    ds_read_b64_tr_b16 v[182:183], v23 offset:50784
    ds_read_b64_tr_b16 v[184:185], v24 offset:96
    ds_read_b64_tr_b16 v[186:187], v24 offset:16992
    ds_read_b64_tr_b16 v[188:189], v24 offset:33888
    ds_read_b64_tr_b16 v[190:191], v24 offset:50784
    s_waitcnt vmcnt(1)
    s_barrier
    ds_read_b128 v[92:95], v20 offset:0
    ds_read_b128 v[96:99], v20 offset:1024
    ds_read_b128 v[100:103], v20 offset:2048
    ds_read_b128 v[104:107], v20 offset:3072
    s_waitcnt lgkmcnt(3)
    v_mfma_f32_16x16x32_bf16 v[48:51], v[128:131], v[92:95], 0
    s_waitcnt lgkmcnt(2)
    v_mfma_f32_16x16x32_bf16 v[48:51], v[132:135], v[96:99], v[48:51]
    s_waitcnt lgkmcnt(1)
    v_mfma_f32_16x16x32_bf16 v[48:51], v[136:139], v[100:103], v[48:51]
    s_waitcnt lgkmcnt(0)
    v_mfma_f32_16x16x32_bf16 v[48:51], v[140:143], v[104:107], v[48:51]
    v_mfma_f32_16x16x32_bf16 v[52:55], v[144:147], v[92:95], 0
    v_mfma_f32_16x16x32_bf16 v[52:55], v[148:151], v[96:99], v[52:55]
    v_mfma_f32_16x16x32_bf16 v[52:55], v[152:155], v[100:103], v[52:55]
    v_mfma_f32_16x16x32_bf16 v[52:55], v[156:159], v[104:107], v[52:55]
    v_mfma_f32_16x16x32_bf16 v[56:59], v[160:163], v[92:95], 0
    v_mfma_f32_16x16x32_bf16 v[56:59], v[164:167], v[96:99], v[56:59]
    s_nop 1
    v_cvt_pk_bf16_f32 v28, v48, v49
    v_cvt_pk_bf16_f32 v29, v50, v51
    v_mfma_f32_16x16x32_bf16 v[56:59], v[168:171], v[100:103], v[56:59]
    v_mfma_f32_16x16x32_bf16 v[56:59], v[172:175], v[104:107], v[56:59]
    v_cvt_pk_bf16_f32 v30, v52, v53
    v_cvt_pk_bf16_f32 v31, v54, v55
    v_mfma_f32_16x16x32_bf16 v[60:63], v[176:179], v[92:95], 0
    v_mfma_f32_16x16x32_bf16 v[60:63], v[180:183], v[96:99], v[60:63]
    v_permlane16_swap_b32 v28, v30
    v_permlane16_swap_b32 v29, v31
    buffer_store_dwordx4 v[28:31], v26, s[40:43], s60 offen offset:0 sc1
    v_mfma_f32_16x16x32_bf16 v[60:63], v[184:187], v[100:103], v[60:63]
    v_mfma_f32_16x16x32_bf16 v[60:63], v[188:191], v[104:107], v[60:63]
    v_cvt_pk_bf16_f32 v32, v56, v57
    v_cvt_pk_bf16_f32 v33, v58, v59
    s_nop 5
    v_cvt_pk_bf16_f32 v34, v60, v61
    v_cvt_pk_bf16_f32 v35, v62, v63
    s_nop 0
    v_permlane16_swap_b32 v32, v34
    v_permlane16_swap_b32 v33, v35
    buffer_store_dwordx4 v[32:35], v26, s[40:43], s60 offen offset:64 sc1
    s_barrier
    s_endpgm
L_SU:
    v_and_b32 v46, 1, v1
    v_cmp_eq_u32 vcc, 1, v46
    v_mov_b32 v47, 0x0c0c0100
    v_mov_b32 v48, 0x01000c0c
    v_cndmask_b32 v47, v47, v48, vcc
    v_mov_b32 v48, 0x0c0c0302
    v_mov_b32 v49, 0x03020c0c
    v_cndmask_b32 v48, v48, v49, vcc
    v_mov_b32 v49, 0x0c0c0c0c
    v_bfe_u32 v46, v1, 1, 2
    v_cmp_eq_u32 vcc, 0, v46
    s_nop 1
    v_cndmask_b32 v8, v49, v47, vcc
    v_cndmask_b32 v12, v49, v48, vcc
    v_cmp_eq_u32 vcc, 1, v46
    s_nop 1
    v_cndmask_b32 v9, v49, v47, vcc
    v_cndmask_b32 v13, v49, v48, vcc
    v_cmp_eq_u32 vcc, 2, v46
    s_nop 1
    v_cndmask_b32 v10, v49, v47, vcc
    v_cndmask_b32 v14, v49, v48, vcc
    v_cmp_eq_u32 vcc, 3, v46
    s_nop 1
    v_cndmask_b32 v11, v49, v47, vcc
    v_cndmask_b32 v15, v49, v48, vcc
    s_lshr_b32 s52, s26, 1
    s_lshl_b32 s52, s52, 2
    s_add_u32 s52, s52, s31
    s_lshl_b32 s52, s52, 12
    s_add_u32 s52, s52, 131072
    s_lshl_b32 s3, s31, 10
    s_add_u32 s3, s3, 16384
    v_lshl_add_u32 v38, v1, 3, s3
    s_barrier
    ds_read_b64 v[42:43], v39
    s_lshl_b32 s3, s31, 20
    s_lshl_b32 s36, s28, 8
    s_add_u32 s3, s3, s36
    s_lshl_b32 s36, s29, 7
    s_add_u32 s3, s3, s36
    s_add_u32 s44, s16, s3
    s_addc_u32 s45, s17, 0
    s_sub_u32 s46, 4194304, s3
    s_mov_b32 s47, 0x20000
    v_lshrrev_b32 v5, 3, v1
    v_and_b32 v6, 7, v1
    v_lshrrev_b32 v4, 4, v1
    v_and_b32 v3, 15, v1
    v_lshlrev_b32 v24, 17, v5
    v_lshl_add_u32 v24, v6, 4, v24
    v_lshlrev_b32 v25, 13, v4
    v_lshl_add_u32 v25, v3, 4, v25
    v_and_b32 v46, 31, v1
    v_lshlrev_b32 v26, 8, v46
    v_lshlrev_b32 v19, 3, v46
    v_add_u32 v19, 22784, v19
    v_and_b32 v36, 24, v1
    s_lshr_b32 s59, s26, 4
    s_lshl_b32 s59, s59, 9
    s_and_b32 s3, s28, 15
    s_add_u32 s59, s59, s3
    s_lshl_b32 s59, s59, 4
    s_add_u32 s59, s59, 1572864
    s_lshl_b32 s3, s31, 6
    s_add_u32 s3, s3, 22528
    v_lshl_add_u32 v37, v46, 1, s3
    v_lshl_add_u32 v23, v4, 4, s3
    s_lshl_b32 s58, s26, 15
    s_lshl_b32 s3, s31, 8
    s_add_u32 s58, s58, s3
    s_add_u32 s58, s58, 2097152
    s_add_u32 s60, s58, 4096
    v_and_b32 v46, 16, v1
    v_lshl_add_u32 v21, v6, 5, v46
    s_add_u32 s54, s3, 20480
    v_add_u32 v21, s54, v21
    s_add_u32 s3, s3, 21504
    v_lshlrev_b32 v20, 4, v3
    v_lshl_add_u32 v20, v4, 3, v20
    v_add_u32 v20, s3, v20
    v_lshl_add_u32 v22, v5, 5, s3
    s_barrier
    s_mov_b32 s33, 0x40000
    s_mov_b32 s39, 0
    buffer_load_dwordx4 v[48:51], v7, s[40:43], s52 offen offset:0 sc1
    buffer_load_dwordx4 v[52:55], v7, s[40:43], s52 offen offset:1024 sc1
    buffer_load_dwordx4 v[56:59], v7, s[40:43], s52 offen offset:2048 sc1
    buffer_load_dwordx4 v[60:63], v7, s[40:43], s52 offen offset:3072 sc1
    s_waitcnt vmcnt(0) lgkmcnt(0)
    s_branch L_U_gq_t
L_U_gq:
    buffer_load_dwordx4 v[48:51], v7, s[40:43], s52 offen offset:0 sc1
    buffer_load_dwordx4 v[52:55], v7, s[40:43], s52 offen offset:1024 sc1
    buffer_load_dwordx4 v[56:59], v7, s[40:43], s52 offen offset:2048 sc1
    buffer_load_dwordx4 v[60:63], v7, s[40:43], s52 offen offset:3072 sc1
    s_waitcnt vmcnt(0)
L_U_gq_t:
    v_cmp_ne_u64 vcc, v[50:51], v[42:43]
    v_cmp_ne_u64 s[54:55], v[54:55], v[42:43]
    s_nop 0
    s_or_b64 vcc, vcc, s[54:55]
    v_cmp_ne_u64 s[54:55], v[58:59], v[42:43]
    s_nop 0
    s_or_b64 vcc, vcc, s[54:55]
    v_cmp_ne_u64 s[54:55], v[62:63], v[42:43]
    s_nop 0
    s_or_b64 vcc, vcc, s[54:55]
    s_cbranch_vccz L_U_gq_ok
    s_sleep 3
    s_sub_u32 s33, s33, 1
    s_cbranch_scc0 L_U_gq
L_U_gq_ok:
    v_add_f32 v48, v48, v56
    v_add_f32 v49, v49, v57
    v_add_f32 v52, v52, v60
    v_add_f32 v53, v53, v61
    ds_write_b64 v38, v[48:49]
    ds_write_b64 v38, v[52:53] offset:512
    s_waitcnt lgkmcnt(0)
    s_barrier
    s_sleep 20
    s_cmp_lg_u32 s31, 3
    s_cbranch_scc1 L_U_n5
    s_lshl_b32 s3, s28, 1
    s_add_u32 s3, s3, s29
    s_mul_i32 s63, s3, 81920
    s_lshl_b32 s3, 4, 8
    s_add_u32 s63, s63, s3
    s_add_u32 s68, s18, s63
    s_addc_u32 s69, s19, 0
    s_sub_u32 s70, 5242880, s63
    s_mov_b32 s71, 0x20000
    v_lshrrev_b32 v47, 4, v1
    v_mul_u32_u24 v6, 20480, v47
    v_and_b32 v46, 15, v1
    v_lshl_add_u32 v6, v46, 4, v6
    s_mov_b32 s64, 0
    buffer_load_dwordx4 v[128:131], v24, s[44:47], s39 offen nt
    s_add_u32 s39, s39, 8192
    buffer_load_dwordx4 v[132:135], v24, s[44:47], s39 offen nt
    s_add_u32 s39, s39, 8192
    buffer_load_dwordx4 v[136:139], v24, s[44:47], s39 offen nt
    s_add_u32 s39, s39, 8192
    buffer_load_dwordx4 v[140:143], v24, s[44:47], s39 offen nt
    s_add_u32 s39, s39, 8192
    buffer_load_dwordx4 v[144:147], v24, s[44:47], s39 offen nt
    s_add_u32 s39, s39, 8192
    buffer_load_dwordx4 v[148:151], v24, s[44:47], s39 offen nt
    s_add_u32 s39, s39, 8192
    buffer_load_dwordx4 v[152:155], v24, s[44:47], s39 offen nt
    s_add_u32 s39, s39, 8192
    buffer_load_dwordx4 v[156:159], v24, s[44:47], s39 offen nt
    s_add_u32 s39, s39, 8192
    s_waitcnt vmcnt(7)
    buffer_load_dwordx4 v[160:163], v24, s[44:47], s39 offen nt
    s_add_u32 s39, s39, 8192
    s_waitcnt vmcnt(7)
    buffer_load_dwordx4 v[164:167], v24, s[44:47], s39 offen nt
    s_add_u32 s39, s39, 8192
    s_waitcnt vmcnt(7)
    buffer_load_dwordx4 v[168:171], v24, s[44:47], s39 offen nt
    s_add_u32 s39, s39, 8192
    s_waitcnt vmcnt(7)
    buffer_load_dwordx4 v[172:175], v24, s[44:47], s39 offen nt
    s_add_u32 s39, s39, 8192
    s_waitcnt vmcnt(7)
    buffer_load_dwordx4 v[176:179], v24, s[44:47], s39 offen nt
    s_add_u32 s39, s39, 8192
    s_waitcnt vmcnt(7)
    buffer_load_dwordx4 v[180:183], v24, s[44:47], s39 offen nt
    s_add_u32 s39, s39, 8192
    s_waitcnt vmcnt(7)
    buffer_load_dwordx4 v[184:187], v24, s[44:47], s39 offen nt
    s_add_u32 s39, s39, 8192
    s_waitcnt vmcnt(7)
    buffer_load_dwordx4 v[188:191], v24, s[44:47], s39 offen nt
    s_add_u32 s39, s39, 8192
    s_waitcnt vmcnt(7)
    buffer_load_dwordx4 v[192:195], v6, s[68:71], s64 offen offset:0 nt
    s_waitcnt vmcnt(7)
    buffer_load_dwordx4 v[196:199], v6, s[68:71], s64 offen offset:1280 nt
    s_waitcnt vmcnt(7)
    buffer_load_dwordx4 v[200:203], v6, s[68:71], s64 offen offset:2560 nt
    s_add_u32 s64, s64, 3840
    s_waitcnt vmcnt(7)
    buffer_load_dwordx4 v[204:207], v6, s[68:71], s64 offen offset:0 nt
    s_waitcnt vmcnt(7)
    buffer_load_dwordx4 v[208:211], v6, s[68:71], s64 offen offset:1280 nt
    s_waitcnt vmcnt(7)
    buffer_load_dwordx4 v[212:215], v6, s[68:71], s64 offen offset:2560 nt
    s_add_u32 s64, s64, 3840
    s_waitcnt vmcnt(7)
    buffer_load_dwordx4 v[216:219], v6, s[68:71], s64 offen offset:0 nt
    s_waitcnt vmcnt(7)
    buffer_load_dwordx4 v[220:223], v6, s[68:71], s64 offen offset:1280 nt
    s_waitcnt vmcnt(7)
    buffer_load_dwordx4 v[224:227], v6, s[68:71], s64 offen offset:2560 nt
    s_add_u32 s64, s64, 3840
    s_waitcnt vmcnt(7)
    buffer_load_dwordx4 v[228:231], v6, s[68:71], s64 offen offset:0 nt
    s_waitcnt vmcnt(7)
    buffer_load_dwordx4 v[232:235], v6, s[68:71], s64 offen offset:1280 nt
    s_waitcnt vmcnt(7)
    buffer_load_dwordx4 v[236:239], v6, s[68:71], s64 offen offset:2560 nt
    s_add_u32 s64, s64, 3840
    s_waitcnt vmcnt(7)
    buffer_load_dwordx4 v[240:243], v6, s[68:71], s64 offen offset:0 nt
    s_waitcnt vmcnt(7)
    buffer_load_dwordx4 v[244:247], v6, s[68:71], s64 offen offset:1280 nt
    s_waitcnt vmcnt(7)
    buffer_load_dwordx4 v[248:251], v6, s[68:71], s64 offen offset:2560 nt
    s_add_u32 s64, s64, 3840
    s_waitcnt vmcnt(7)
    buffer_load_dwordx4 v[252:255], v6, s[68:71], s64 offen offset:0 nt
    s_branch L_U_n5d
L_U_n5:
    buffer_load_dwordx4 v[128:131], v24, s[44:47], s39 offen nt
    s_add_u32 s39, s39, 8192
    buffer_load_dwordx4 v[132:135], v24, s[44:47], s39 offen nt
    s_add_u32 s39, s39, 8192
    buffer_load_dwordx4 v[136:139], v24, s[44:47], s39 offen nt
    s_add_u32 s39, s39, 8192
    buffer_load_dwordx4 v[140:143], v24, s[44:47], s39 offen nt
    s_add_u32 s39, s39, 8192
    s_waitcnt vmcnt(3)
    buffer_load_dwordx4 v[144:147], v24, s[44:47], s39 offen nt
    s_add_u32 s39, s39, 8192
    s_waitcnt vmcnt(3)
    buffer_load_dwordx4 v[148:151], v24, s[44:47], s39 offen nt
    s_add_u32 s39, s39, 8192
    s_waitcnt vmcnt(3)
    buffer_load_dwordx4 v[152:155], v24, s[44:47], s39 offen nt
    s_add_u32 s39, s39, 8192
    s_waitcnt vmcnt(3)
    buffer_load_dwordx4 v[156:159], v24, s[44:47], s39 offen nt
    s_add_u32 s39, s39, 8192
    s_waitcnt vmcnt(3)
    buffer_load_dwordx4 v[160:163], v24, s[44:47], s39 offen nt
    s_add_u32 s39, s39, 8192
    s_waitcnt vmcnt(3)
    buffer_load_dwordx4 v[164:167], v24, s[44:47], s39 offen nt
    s_add_u32 s39, s39, 8192
    s_waitcnt vmcnt(3)
    buffer_load_dwordx4 v[168:171], v24, s[44:47], s39 offen nt
    s_add_u32 s39, s39, 8192
    s_waitcnt vmcnt(3)
    buffer_load_dwordx4 v[172:175], v24, s[44:47], s39 offen nt
    s_add_u32 s39, s39, 8192
    s_waitcnt vmcnt(3)
    buffer_load_dwordx4 v[176:179], v24, s[44:47], s39 offen nt
    s_add_u32 s39, s39, 8192
    s_waitcnt vmcnt(3)
    buffer_load_dwordx4 v[180:183], v24, s[44:47], s39 offen nt
    s_add_u32 s39, s39, 8192
    s_waitcnt vmcnt(3)
    buffer_load_dwordx4 v[184:187], v24, s[44:47], s39 offen nt
    s_add_u32 s39, s39, 8192
    s_waitcnt vmcnt(3)
    buffer_load_dwordx4 v[188:191], v24, s[44:47], s39 offen nt
    s_add_u32 s39, s39, 8192
L_U_n5d:
    s_cmp_lg_u32 s31, 0
    s_cbranch_scc1 L_U_wait
    s_mov_b32 s33, 0x40000
L_U_gn:
    buffer_load_dwordx2 v[40:41], v36, s[48:51], s67 offen offset:192 sc1
    s_waitcnt vmcnt(0)
    v_cmp_eq_u32 vcc, 0, v40
    s_cbranch_vccz L_U_gn_ok
    s_sleep 8
    s_sub_u32 s33, s33, 1
    s_cbranch_scc0 L_U_gn
L_U_gn_ok:
    s_mov_b32 s33, 0x40000
    buffer_load_dwordx4 v[84:87], v26, s[40:43], s59 offen sc1
L_U_gs:
    s_sleep 1
    buffer_load_dwordx4 v[80:83], v26, s[40:43], s59 offen sc1
    s_waitcnt vmcnt(1)
    v_cmp_ne_u64 vcc, v[86:87], v[40:41]
    s_cbranch_vccz L_U_gs_b
    s_sleep 1
    buffer_load_dwordx4 v[84:87], v26, s[40:43], s59 offen sc1
    s_waitcnt vmcnt(1)
    v_cmp_ne_u64 vcc, v[82:83], v[40:41]
    s_cbranch_vccz L_U_gs_a
    s_sub_u32 s33, s33, 1
    s_cbranch_scc0 L_U_gs
L_U_gs_a:
    ds_write_b64 v19, v[80:81]
    s_branch L_U_gs_c
L_U_gs_b:
    ds_write_b64 v19, v[84:85]
L_U_gs_c:
    v_mov_b32 v45, 1
    ds_write_b32 v39, v45 offset:8
    s_branch L_U_gs_ok
L_U_wait:
    s_mov_b32 s33, 0x400000
L_U_wl:
    ds_read_b32 v45, v39 offset:8
    s_waitcnt lgkmcnt(0)
    v_cmp_ne_u32 vcc, 0, v45
    s_cbranch_vccnz L_U_gs_ok
    s_sleep 1
    s_sub_u32 s33, s33, 1
    s_cbranch_scc0 L_U_wl
L_U_gs_ok:
    buffer_load_dwordx4 v[48:51], v25, s[40:43], s58 offen offset:0 sc1
    buffer_load_dwordx4 v[52:55], v25, s[40:43], s58 offen offset:1024 sc1
    buffer_load_dwordx4 v[56:59], v25, s[40:43], s58 offen offset:2048 sc1
    buffer_load_dwordx4 v[60:63], v25, s[40:43], s58 offen offset:3072 sc1
    buffer_load_dwordx4 v[64:67], v25, s[40:43], s60 offen offset:0 sc1
    buffer_load_dwordx4 v[68:71], v25, s[40:43], s60 offen offset:1024 sc1
    buffer_load_dwordx4 v[72:75], v25, s[40:43], s60 offen offset:2048 sc1
    buffer_load_dwordx4 v[76:79], v25, s[40:43], s60 offen offset:3072 sc1
    ds_read_b64 v[88:89], v19
    s_waitcnt lgkmcnt(0)
    v_mov_b32 v44, v88
    s_nop 1
    v_max_f32_dpp v44, v44, v44 quad_perm:[1,0,3,2] row_mask:0xf bank_mask:0xf
    s_nop 1
    v_max_f32_dpp v44, v44, v44 quad_perm:[2,3,0,1] row_mask:0xf bank_mask:0xf
    s_nop 1
    v_max_f32_dpp v44, v44, v44 row_half_mirror row_mask:0xf bank_mask:0xf
    s_nop 1
    v_max_f32_dpp v44, v44, v44 row_ror:8 row_mask:0xf bank_mask:0xf
    v_mov_b32 v45, v44
    s_nop 1
    v_permlane16_swap_b32 v44, v45
    v_max_f32 v44, v44, v45
    v_sub_f32 v88, v88, v44
    v_exp_f32 v88, v88
    s_nop 0
    v_cvt_pk_bf16_f32 v45, v88, v88
    ds_write_b16 v37, v45
    ds_read_b128 v[28:31], v23
    v_mul_f32 v44, v88, v89
    s_nop 1
    v_add_f32_dpp v44, v44, v44 quad_perm:[1,0,3,2] row_mask:0xf bank_mask:0xf
    s_nop 1
    v_add_f32_dpp v44, v44, v44 quad_perm:[2,3,0,1] row_mask:0xf bank_mask:0xf
    s_nop 1
    v_add_f32_dpp v44, v44, v44 row_half_mirror row_mask:0xf bank_mask:0xf
    s_nop 1
    v_add_f32_dpp v44, v44, v44 row_ror:8 row_mask:0xf bank_mask:0xf
    v_mov_b32 v45, v44
    s_nop 1
    v_permlane16_swap_b32 v44, v45
    v_add_f32 v44, v44, v45
    v_rcp_f32 v44, v44
    s_waitcnt lgkmcnt(0)
    v_perm_b32 v92, v28, v28, v8
    v_perm_b32 v93, v28, v28, v9
    v_perm_b32 v94, v28, v28, v10
    v_perm_b32 v95, v28, v28, v11
    v_perm_b32 v96, v28, v28, v12
    v_perm_b32 v97, v28, v28, v13
    v_perm_b32 v98, v28, v28, v14
    v_perm_b32 v99, v28, v28, v15
    v_perm_b32 v100, v29, v29, v8
    v_perm_b32 v101, v29, v29, v9
    v_perm_b32 v102, v29, v29, v10
    v_perm_b32 v103, v29, v29, v11
    v_perm_b32 v104, v29, v29, v12
    v_perm_b32 v105, v29, v29, v13
    v_perm_b32 v106, v29, v29, v14
    v_perm_b32 v107, v29, v29, v15
    v_perm_b32 v108, v30, v30, v8
    v_perm_b32 v109, v30, v30, v9
    v_perm_b32 v110, v30, v30, v10
    v_perm_b32 v111, v30, v30, v11
    v_perm_b32 v112, v30, v30, v12
    v_perm_b32 v113, v30, v30, v13
    v_perm_b32 v114, v30, v30, v14
    v_perm_b32 v115, v30, v30, v15
    v_perm_b32 v116, v31, v31, v8
    v_perm_b32 v117, v31, v31, v9
    v_perm_b32 v118, v31, v31, v10
    v_perm_b32 v119, v31, v31, v11
    v_perm_b32 v120, v31, v31, v12
    v_perm_b32 v121, v31, v31, v13
    v_perm_b32 v122, v31, v31, v14
    v_perm_b32 v123, v31, v31, v15
    s_mov_b32 s33, 0x40000
L_U_gb:
    s_waitcnt vmcnt(7)
    v_mfma_f32_16x16x32_bf16 v[32:35], v[92:95], v[48:51], 0
    v_max3_u32 v43, v48, v49, v50
    v_max_u32 v43, v43, v51
    s_waitcnt vmcnt(6)
    v_mfma_f32_16x16x32_bf16 v[32:35], v[96:99], v[52:55], v[32:35]
    v_max3_u32 v43, v43, v52, v53
    v_max3_u32 v43, v43, v54, v55
    s_waitcnt vmcnt(5)
    v_mfma_f32_16x16x32_bf16 v[32:35], v[100:103], v[56:59], v[32:35]
    v_max3_u32 v43, v43, v56, v57
    v_max3_u32 v43, v43, v58, v59
    s_waitcnt vmcnt(4)
    v_mfma_f32_16x16x32_bf16 v[32:35], v[104:107], v[60:63], v[32:35]
    v_max3_u32 v43, v43, v60, v61
    v_max3_u32 v43, v43, v62, v63
    s_waitcnt vmcnt(3)
    v_mfma_f32_16x16x32_bf16 v[32:35], v[108:111], v[64:67], v[32:35]
    v_max3_u32 v43, v43, v64, v65
    v_max3_u32 v43, v43, v66, v67
    s_waitcnt vmcnt(2)
    v_mfma_f32_16x16x32_bf16 v[32:35], v[112:115], v[68:71], v[32:35]
    v_max3_u32 v43, v43, v68, v69
    v_max3_u32 v43, v43, v70, v71
    s_waitcnt vmcnt(1)
    v_mfma_f32_16x16x32_bf16 v[32:35], v[116:119], v[72:75], v[32:35]
    v_max3_u32 v43, v43, v72, v73
    v_max3_u32 v43, v43, v74, v75
    s_waitcnt vmcnt(0)
    v_mfma_f32_16x16x32_bf16 v[32:35], v[120:123], v[76:79], v[32:35]
    v_max3_u32 v43, v43, v76, v77
    v_max3_u32 v43, v43, v78, v79
    v_cmp_eq_u32 vcc, -1, v43
    s_cbranch_vccz L_U_gb_ok
    buffer_load_dwordx4 v[48:51], v25, s[40:43], s58 offen offset:0 sc1
    buffer_load_dwordx4 v[52:55], v25, s[40:43], s58 offen offset:1024 sc1
    buffer_load_dwordx4 v[56:59], v25, s[40:43], s58 offen offset:2048 sc1
    buffer_load_dwordx4 v[60:63], v25, s[40:43], s58 offen offset:3072 sc1
    buffer_load_dwordx4 v[64:67], v25, s[40:43], s60 offen offset:0 sc1
    buffer_load_dwordx4 v[68:71], v25, s[40:43], s60 offen offset:1024 sc1
    buffer_load_dwordx4 v[72:75], v25, s[40:43], s60 offen offset:2048 sc1
    buffer_load_dwordx4 v[76:79], v25, s[40:43], s60 offen offset:3072 sc1
    s_sub_u32 s33, s33, 1
    s_cbranch_scc0 L_U_gb
L_U_gb_ok:
    s_nop 3
    v_cvt_pk_bf16_f32 v32, v32, v33
    v_cvt_pk_bf16_f32 v33, v34, v35
    s_mov_b32 exec_hi, 0
    ds_write_b64 v20, v[32:33]
    s_mov_b32 exec_hi, -1
    ds_read_b128 v[48:51], v22 offset:0
    ds_read_b128 v[52:55], v22 offset:16
    s_waitcnt lgkmcnt(0)
    v_perm_b32 v72, v48, v48, v8
    v_perm_b32 v73, v48, v48, v9
    v_perm_b32 v74, v48, v48, v10
    v_perm_b32 v75, v48, v48, v11
    v_perm_b32 v76, v48, v48, v12
    v_perm_b32 v77, v48, v48, v13
    v_perm_b32 v78, v48, v48, v14
    v_perm_b32 v79, v48, v48, v15
    v_mfma_f32_16x16x32_bf16 v[32:35], v[72:75], v[128:131], 0
    v_perm_b32 v72, v49, v49, v8
    v_perm_b32 v73, v49, v49, v9
    v_perm_b32 v74, v49, v49, v10
    v_perm_b32 v75, v49, v49, v11
    v_mfma_f32_16x16x32_bf16 v[32:35], v[76:79], v[132:135], v[32:35]
    v_perm_b32 v76, v49, v49, v12
    v_perm_b32 v77, v49, v49, v13
    v_perm_b32 v78, v49, v49, v14
    v_perm_b32 v79, v49, v49, v15
    v_mfma_f32_16x16x32_bf16 v[32:35], v[72:75], v[136:139], v[32:35]
    v_perm_b32 v72, v50, v50, v8
    v_perm_b32 v73, v50, v50, v9
    v_perm_b32 v74, v50, v50, v10
    v_perm_b32 v75, v50, v50, v11
    v_mfma_f32_16x16x32_bf16 v[32:35], v[76:79], v[140:143], v[32:35]
    v_perm_b32 v76, v50, v50, v12
    v_perm_b32 v77, v50, v50, v13
    v_perm_b32 v78, v50, v50, v14
    v_perm_b32 v79, v50, v50, v15
    v_mfma_f32_16x16x32_bf16 v[32:35], v[72:75], v[144:147], v[32:35]
    v_perm_b32 v72, v51, v51, v8
    v_perm_b32 v73, v51, v51, v9
    v_perm_b32 v74, v51, v51, v10
    v_perm_b32 v75, v51, v51, v11
    v_mfma_f32_16x16x32_bf16 v[32:35], v[76:79], v[148:151], v[32:35]
    v_perm_b32 v76, v51, v51, v12
    v_perm_b32 v77, v51, v51, v13
    v_perm_b32 v78, v51, v51, v14
    v_perm_b32 v79, v51, v51, v15
    v_mfma_f32_16x16x32_bf16 v[32:35], v[72:75], v[152:155], v[32:35]
    v_perm_b32 v72, v52, v52, v8
    v_perm_b32 v73, v52, v52, v9
    v_perm_b32 v74, v52, v52, v10
    v_perm_b32 v75, v52, v52, v11
    v_mfma_f32_16x16x32_bf16 v[32:35], v[76:79], v[156:159], v[32:35]
    v_perm_b32 v76, v52, v52, v12
    v_perm_b32 v77, v52, v52, v13
    v_perm_b32 v78, v52, v52, v14
    v_perm_b32 v79, v52, v52, v15
    v_mfma_f32_16x16x32_bf16 v[32:35], v[72:75], v[160:163], v[32:35]
    v_perm_b32 v72, v53, v53, v8
    v_perm_b32 v73, v53, v53, v9
    v_perm_b32 v74, v53, v53, v10
    v_perm_b32 v75, v53, v53, v11
    v_mfma_f32_16x16x32_bf16 v[32:35], v[76:79], v[164:167], v[32:35]
    v_perm_b32 v76, v53, v53, v12
    v_perm_b32 v77, v53, v53, v13
    v_perm_b32 v78, v53, v53, v14
    v_perm_b32 v79, v53, v53, v15
    v_mfma_f32_16x16x32_bf16 v[32:35], v[72:75], v[168:171], v[32:35]
    v_perm_b32 v72, v54, v54, v8
    v_perm_b32 v73, v54, v54, v9
    v_perm_b32 v74, v54, v54, v10
    v_perm_b32 v75, v54, v54, v11
    v_mfma_f32_16x16x32_bf16 v[32:35], v[76:79], v[172:175], v[32:35]
    v_perm_b32 v76, v54, v54, v12
    v_perm_b32 v77, v54, v54, v13
    v_perm_b32 v78, v54, v54, v14
    v_perm_b32 v79, v54, v54, v15
    v_mfma_f32_16x16x32_bf16 v[32:35], v[72:75], v[176:179], v[32:35]
    v_perm_b32 v72, v55, v55, v8
    v_perm_b32 v73, v55, v55, v9
    v_perm_b32 v74, v55, v55, v10
    v_perm_b32 v75, v55, v55, v11
    v_mfma_f32_16x16x32_bf16 v[32:35], v[76:79], v[180:183], v[32:35]
    v_perm_b32 v76, v55, v55, v12
    v_perm_b32 v77, v55, v55, v13
    v_perm_b32 v78, v55, v55, v14
    v_perm_b32 v79, v55, v55, v15
    v_mfma_f32_16x16x32_bf16 v[32:35], v[72:75], v[184:187], v[32:35]
    s_nop 0
    v_mfma_f32_16x16x32_bf16 v[32:35], v[76:79], v[188:191], v[32:35]
    s_nop 7
    v_mov_b32 v88, v32
    v_mov_b32 v89, v33
    v_mov_b32 v90, v34
    v_mov_b32 v91, v35
    v_permlane32_swap_b32 v32, v88
    v_permlane32_swap_b32 v33, v89
    v_permlane32_swap_b32 v34, v90
    v_permlane32_swap_b32 v35, v91
    v_add_f32_dpp v32, v88, v32 row_ror:8 row_mask:0xf bank_mask:0xf
    v_add_f32_dpp v33, v89, v33 row_ror:8 row_mask:0xf bank_mask:0xf
    v_add_f32_dpp v34, v90, v34 row_ror:8 row_mask:0xf bank_mask:0xf
    v_add_f32_dpp v35, v91, v35 row_ror:8 row_mask:0xf bank_mask:0xf
    v_mul_f32 v32, v32, v44
    v_mul_f32 v33, v33, v44
    v_mul_f32 v34, v34, v44
    v_mul_f32 v35, v35, v44
    s_mov_b64 exec, 0x00ff00ff
    ds_write_b128 v21, v[32:35]
    s_mov_b64 exec, -1
    s_waitcnt lgkmcnt(0)
    s_cmp_lg_u32 s31, 3
    s_cbranch_scc1 L_U_last
    v_lshlrev_b32 v44, 2, v1
    v_add_u32 v44, 20480, v44
    s_lshl_b32 s3, 4, 7
    s_add_u32 s3, s3, 0
    v_lshl_add_u32 v46, v1, 1, s3
    v_lshrrev_b32 v47, 4, v1
    v_lshl_add_u32 v47, v47, 5, s3
    v_and_b32 v45, 15, v1
    v_lshlrev_b32 v45, 6, v45
    v_and_b32 v48, 16, v1
    v_lshl_add_u32 v45, v48, 1, v45
    v_lshrrev_b32 v48, 5, v1
    v_lshl_add_u32 v45, v48, 4, v45
    s_lshl_b32 s62, s26, 1
    s_add_u32 s62, s62, s29
    s_mul_i32 s62, s62, 5
    s_add_u32 s62, s62, 4
    s_lshl_b32 s62, s62, 10
    s_add_u32 s62, s62, 786432
    ds_read_b64 v[26:27], v39
    s_barrier
    ds_read_b32 v80, v44 offset:0
    ds_read_b32 v81, v44 offset:256
    ds_read_b32 v82, v44 offset:512
    ds_read_b32 v83, v44 offset:768
    s_waitcnt lgkmcnt(0)
    v_add_f32 v80, v80, v81
    v_add_f32 v82, v82, v83
    v_add_f32 v80, v80, v82
    v_cvt_pk_bf16_f32 v80, v80, v80
    ds_write_b16 v46, v80
    ds_read_b128 v[56:59], v47
    ds_read_b128 v[60:63], v47 offset:16
    s_waitcnt lgkmcnt(0)
    v_perm_b32 v64, v56, v56, v8
    v_perm_b32 v65, v56, v56, v9
    v_perm_b32 v66, v56, v56, v10
    v_perm_b32 v67, v56, v56, v11
    v_perm_b32 v68, v56, v56, v12
    v_perm_b32 v69, v56, v56, v13
    v_perm_b32 v70, v56, v56, v14
    v_perm_b32 v71, v56, v56, v15
    v_mfma_f32_16x16x32_bf16 v[72:75], v[64:67], v[192:195], 0
    v_perm_b32 v64, v57, v57, v8
    v_perm_b32 v65, v57, v57, v9
    v_perm_b32 v66, v57, v57, v10
    v_perm_b32 v67, v57, v57, v11
    v_mfma_f32_16x16x32_bf16 v[72:75], v[68:71], v[196:199], v[72:75]
    v_perm_b32 v68, v57, v57, v12
    v_perm_b32 v69, v57, v57, v13
    v_perm_b32 v70, v57, v57, v14
    v_perm_b32 v71, v57, v57, v15
    v_mfma_f32_16x16x32_bf16 v[72:75], v[64:67], v[200:203], v[72:75]
    v_perm_b32 v64, v58, v58, v8
    v_perm_b32 v65, v58, v58, v9
    v_perm_b32 v66, v58, v58, v10
    v_perm_b32 v67, v58, v58, v11
    v_mfma_f32_16x16x32_bf16 v[72:75], v[68:71], v[204:207], v[72:75]
    v_perm_b32 v68, v58, v58, v12
    v_perm_b32 v69, v58, v58, v13
    v_perm_b32 v70, v58, v58, v14
    v_perm_b32 v71, v58, v58, v15
    v_mfma_f32_16x16x32_bf16 v[72:75], v[64:67], v[208:211], v[72:75]
    v_perm_b32 v64, v59, v59, v8
    v_perm_b32 v65, v59, v59, v9
    v_perm_b32 v66, v59, v59, v10
    v_perm_b32 v67, v59, v59, v11
    v_mfma_f32_16x16x32_bf16 v[72:75], v[68:71], v[212:215], v[72:75]
    v_perm_b32 v68, v59, v59, v12
    v_perm_b32 v69, v59, v59, v13
    v_perm_b32 v70, v59, v59, v14
    v_perm_b32 v71, v59, v59, v15
    v_mfma_f32_16x16x32_bf16 v[72:75], v[64:67], v[216:219], v[72:75]
    v_perm_b32 v64, v60, v60, v8
    v_perm_b32 v65, v60, v60, v9
    v_perm_b32 v66, v60, v60, v10
    v_perm_b32 v67, v60, v60, v11
    v_mfma_f32_16x16x32_bf16 v[72:75], v[68:71], v[220:223], v[72:75]
    v_perm_b32 v68, v60, v60, v12
    v_perm_b32 v69, v60, v60, v13
    v_perm_b32 v70, v60, v60, v14
    v_perm_b32 v71, v60, v60, v15
    v_mfma_f32_16x16x32_bf16 v[72:75], v[64:67], v[224:227], v[72:75]
    v_perm_b32 v64, v61, v61, v8
    v_perm_b32 v65, v61, v61, v9
    v_perm_b32 v66, v61, v61, v10
    v_perm_b32 v67, v61, v61, v11
    v_mfma_f32_16x16x32_bf16 v[72:75], v[68:71], v[228:231], v[72:75]
    v_perm_b32 v68, v61, v61, v12
    v_perm_b32 v69, v61, v61, v13
    v_perm_b32 v70, v61, v61, v14
    v_perm_b32 v71, v61, v61, v15
    v_mfma_f32_16x16x32_bf16 v[72:75], v[64:67], v[232:235], v[72:75]
    v_perm_b32 v64, v62, v62, v8
    v_perm_b32 v65, v62, v62, v9
    v_perm_b32 v66, v62, v62, v10
    v_perm_b32 v67, v62, v62, v11
    v_mfma_f32_16x16x32_bf16 v[72:75], v[68:71], v[236:239], v[72:75]
    v_perm_b32 v68, v62, v62, v12
    v_perm_b32 v69, v62, v62, v13
    v_perm_b32 v70, v62, v62, v14
    v_perm_b32 v71, v62, v62, v15
    v_mfma_f32_16x16x32_bf16 v[72:75], v[64:67], v[240:243], v[72:75]
    v_perm_b32 v64, v63, v63, v8
    v_perm_b32 v65, v63, v63, v9
    v_perm_b32 v66, v63, v63, v10
    v_perm_b32 v67, v63, v63, v11
    v_mfma_f32_16x16x32_bf16 v[72:75], v[68:71], v[244:247], v[72:75]
    v_perm_b32 v68, v63, v63, v12
    v_perm_b32 v69, v63, v63, v13
    v_perm_b32 v70, v63, v63, v14
    v_perm_b32 v71, v63, v63, v15
    v_mfma_f32_16x16x32_bf16 v[72:75], v[64:67], v[248:251], v[72:75]
    s_nop 0
    v_mfma_f32_16x16x32_bf16 v[72:75], v[68:71], v[252:255], v[72:75]
    s_nop 7
    v_mov_b32 v24, v72
    v_mov_b32 v25, v73
    v_mov_b32_dpp v24, v74 quad_perm:[0,1,2,3] row_mask:0xc bank_mask:0xf
    v_mov_b32_dpp v25, v75 quad_perm:[0,1,2,3] row_mask:0xc bank_mask:0xf
    buffer_store_dwordx4 v[24:27], v45, s[40:43], s62 offen sc1
    s_endpgm
L_U_last:
    s_barrier
L_end:
    s_endpgm
.org concat_heads__compressed_kv_cla__compressed_kv_cla__decode_kernel+16384, 0
.section .rodata,"a"
.p2align 6
.amdhsa_kernel concat_heads__compressed_kv_cla__compressed_kv_cla__decode_kernel
  .amdhsa_next_free_vgpr 256
  .amdhsa_next_free_sgpr 96
  .amdhsa_accum_offset 256
  .amdhsa_group_segment_fixed_size 0
  .amdhsa_kernarg_size 120
  .amdhsa_user_sgpr_count 2
  .amdhsa_user_sgpr_kernarg_segment_ptr 1
  .amdhsa_system_sgpr_workgroup_id_x 1
.end_amdhsa_kernel
```
